```python
import torch

def _softmax(x, axis=-1):
    return torch.softmax(x, dim=axis)
def _gelu(x):
    return torch.nn.functional.gelu(x, approximate="tanh")
def _silu(x):
    return torch.nn.functional.silu(x)
def _sigmoid(x):
    return torch.sigmoid(x)
def _layernorm(x, axis=-1, eps=1e-5):
    m = x.mean(dim=axis, keepdim=True)
    v = x.var(dim=axis, keepdim=True, unbiased=False)
    return (x - m) / torch.sqrt(v + eps)
def _scatter_add(tgt, idx, src, axis=0):
    return tgt.clone().index_add_(axis, idx, src)
def _segment_sum(src, seg, n):
    out = torch.zeros((n,) + src.shape[1:], dtype=src.dtype)
    return out.index_add_(0, seg, src)
def _pad(x, pw):
    flat = tuple(v for pair in reversed(pw) for v in pair)
    return torch.nn.functional.pad(x, flat)

kernel_name = 'concat_heads__mha_block__softmax_full_mha__prompt'

def setup_inputs():

    _w = (lambda a: (lambda t: t.to(torch.bfloat16) if t.is_floating_point() else t)(torch.as_tensor(a)))
    def _A_setup():
        B, S, D, H = 1, 2048, 1024, 32
        return {
            "x": _w((lambda *s: torch.randn(*s, dtype=torch.bfloat16) * 0.2)(B, S, D)),
            "wqkv": _w((lambda *s: torch.randn(*s, dtype=torch.bfloat16) * 0.2)(D, 3 * D)),
            "wo": _w((lambda *s: torch.randn(*s, dtype=torch.bfloat16) * 0.05)(D, D)),
        }
    _A_in = _A_setup()

    def _B_setup():
        B, S, D = 1, 2048, 1024
        return {
            "x": _w((lambda *s: torch.randn(*s, dtype=torch.bfloat16) * 0.2)(B, S, D)),
            "wqkv": _w((lambda *s: torch.randn(*s, dtype=torch.bfloat16) * 0.2)(D, 3 * D)),
            "wo": _w((lambda *s: torch.randn(*s, dtype=torch.bfloat16) * 0.05)(D, D)),
        }
    _B_in = _B_setup()

    return {
        "A_x": _A_in["x"],
        "A_wqkv": _A_in["wqkv"],
        "A_wo": _A_in["wo"],
        "B_x": _B_in["x"],
        "B_wqkv": _B_in["wqkv"],
        "B_wo": _B_in["wo"],
    }

def reference(A_x, A_wqkv, A_wo, B_x, B_wqkv, B_wo):
    def _A_ref(x, wqkv, wo):
        B, S, D = x.shape
        H = 32
        Dh = D // H
        qkv = (lambda x, *d: x.permute(*d))((x @ wqkv).reshape(B, S, 3, H, Dh), 2, 0, 3, 1, 4)
        q, k, v = qkv[0], qkv[1], qkv[2]
        scores = torch.einsum("bhqd,bhkd->bhqk", q, k) * (Dh ** -0.5)
        p = _softmax(scores, axis=-1)
        o = torch.einsum("bhqk,bhkd->bhqd", p, v)
        return (lambda x, *d: x.permute(*d))(o, 0, 2, 1, 3).reshape(B, S, D) @ wo

    def _B_ref(x, wqkv, wo):
        B, S, D = x.shape
        H = 32; Dh = D // H
        qkv = (lambda x, *d: x.permute(*d))((x @ wqkv).reshape(B, S, 3, H, Dh), 2, 0, 3, 1, 4)
        q, k, v = qkv[0], qkv[1], qkv[2]
        scale = Dh ** -0.5
        scores = torch.einsum("bhqd,bhkd->bhqk", q, k) * scale
        p = _softmax(scores, axis=-1)
        o = torch.einsum("bhqk,bhkd->bhqd", p, v)
        return (lambda x, *d: x.permute(*d))(o, 0, 2, 1, 3).reshape(B, S, D) @ wo

    a = _A_ref(A_x, A_wqkv, A_wo)
    b = _B_ref(B_x, B_wqkv, B_wo)
    return torch.concatenate([a, b], axis=-1)
```

```asm
; @launch grid=(256,1,1) block=(512,1,1) lds=163840
.amdgcn_target "amdgcn-amd-amdhsa--gfx950"
.text
.globl concat_heads__mha_block__softmax_full_mha__prompt_kernel
.p2align 8
.type concat_heads__mha_block__softmax_full_mha__prompt_kernel,@function
concat_heads__mha_block__softmax_full_mha__prompt_kernel:
  s_cmp_ge_u32 s2, 256
  s_cbranch_scc1 L_end
  s_load_dwordx16 s[16:31], s[0:1], 0
  s_load_dwordx2 s[32:33], s[0:1], 64
  s_memrealtime s[34:35]
  v_lshrrev_b32 v1, 6, v0
  v_and_b32 v0, 63, v0
  v_readfirstlane_b32 s3, v1
  s_and_b32 s7, s2, 7
  s_lshr_b32 s6, s2, 3
  s_lshr_b32 s4, s7, 2
  s_and_b32 s5, s7, 3
  s_lshl_b32 s5, s5, 2
  s_and_b32 s7, s6, 3
  s_or_b32 s5, s5, s7
  s_lshr_b32 s6, s6, 2
  s_and_b32 s40, s3, 3
  s_lshr_b32 s41, s3, 2
  s_mul_i32 s47, s40, 7
  s_add_u32 s7, s40, 28
  s_cmp_eq_u32 s41, 0
  s_cselect_b32 s47, s7, s47
  v_lshrrev_b32 v11, 3, v0
  s_lshl_b32 s7, s47, 3
  v_add_u32 v15, s7, v11
  v_lshlrev_b32 v15, 11, v15
  v_and_b32 v12, 7, v0
  v_lshrrev_b32 v13, 4, v0
  v_xor_b32 v14, v12, v13
  s_and_b32 s7, s40, 1
  s_lshl_b32 s7, s7, 2
  v_xor_b32 v14, s7, v14
  v_lshl_add_u32 v8, v14, 4, v15
  s_lshl_b32 s47, s47, 10
  s_lshl_b32 s7, s40, 4
  v_add_u32 v11, s7, v11
  v_mul_u32_u24 v11, 6144, v11
  v_and_b32 v13, 1, v13
  v_lshlrev_b32 v13, 2, v13
  v_xor_b32 v14, v12, v13
  v_lshl_add_u32 v6, v14, 4, v11
  v_xor_b32 v7, 32, v6
  v_add_u32 v7, 49152, v7
  s_mul_i32 s48, s40, 6144
  s_add_u32 s48, s48, 98304
  s_mov_b32 s43, 0
  s_mov_b32 s44, 0
  s_mov_b32 s11, 0x20000
  s_mov_b32 s15, 0x20000
  s_mov_b32 s39, 0x20000
  s_mov_b32 s55, 0x20000
  v_mov_b32 v237, 0
  s_waitcnt lgkmcnt(0)
  s_cmp_eq_u32 s4, 0
  s_cselect_b32 s8, s16, s22
  s_cselect_b32 s9, s17, s23
  s_cselect_b32 s12, s18, s24
  s_cselect_b32 s13, s19, s25
  s_lshl_b32 s7, s6, 19
  s_add_u32 s8, s8, s7
  s_addc_u32 s9, s9, 0
  s_sub_u32 s10, 0x400000, s7
  s_lshl_b32 s7, s5, 7
  s_add_u32 s12, s12, s7
  s_addc_u32 s13, s13, 0
  s_sub_u32 s14, 0x600000, s7
  s_cmp_lg_u32 s41, 0
  s_cbranch_scc1 L_proB
  s_add_u32 m0, s48, 0
  s_nop 0
  buffer_load_dwordx4 v6, s[12:15], s44 offen offset:0  lds
  s_add_u32 s46, s44, 1024
  buffer_load_dwordx4 v6, s[12:15], s46 offen offset:1024  lds
  s_add_u32 s45, s44, 2048
  buffer_load_dwordx4 v6, s[12:15], s45 offen offset:2048  lds
  s_add_u32 m0, s48, 3072
  s_nop 0
  buffer_load_dwordx4 v7, s[12:15], s44 offen offset:0  lds
  s_add_u32 s46, s44, 1024
  buffer_load_dwordx4 v7, s[12:15], s46 offen offset:1024  lds
  s_add_u32 s45, s44, 2048
  buffer_load_dwordx4 v7, s[12:15], s45 offen offset:2048  lds
  s_add_u32 s44, s44, 393216
  s_add_u32 m0, s47, 0
  s_nop 0
  buffer_load_dwordx4 v8, s[8:11], s43 offen  lds
  s_add_u32 s43, s43, 128
  s_add_u32 m0, s48, 24576
  s_nop 0
  buffer_load_dwordx4 v6, s[12:15], s44 offen offset:0  lds
  s_add_u32 s46, s44, 1024
  buffer_load_dwordx4 v6, s[12:15], s46 offen offset:1024  lds
  s_add_u32 s45, s44, 2048
  buffer_load_dwordx4 v6, s[12:15], s45 offen offset:2048  lds
  s_add_u32 m0, s48, 27648
  s_nop 0
  buffer_load_dwordx4 v7, s[12:15], s44 offen offset:0  lds
  s_add_u32 s46, s44, 1024
  buffer_load_dwordx4 v7, s[12:15], s46 offen offset:1024  lds
  s_add_u32 s45, s44, 2048
  buffer_load_dwordx4 v7, s[12:15], s45 offen offset:2048  lds
  s_add_u32 s44, s44, 393216
  s_add_u32 m0, s47, 32768
  s_nop 0
  buffer_load_dwordx4 v8, s[8:11], s43 offen  lds
  s_add_u32 s43, s43, 128
  s_add_u32 m0, s47, 65536
  s_nop 0
  buffer_load_dwordx4 v8, s[8:11], s43 offen  lds
  s_add_u32 s43, s43, 128
  s_or_b32 s7, s2, s3
  s_cmp_lg_u32 s7, 0
  s_cbranch_scc1 L_pro2
  s_mov_b32 s52, s30
  s_mov_b32 s53, s31
  s_mov_b32 s54, 256
  s_or_b32 s34, s34, 1
  v_mov_b32 v238, s34
  v_mov_b32 v239, s35
  s_mov_b64 exec, 1
  buffer_store_dwordx2 v[238:239], v237, s[52:55], 0 offen sc1
  s_mov_b64 exec, -1
  s_branch L_pro2
L_proB:
  v_xor_b32 v7, 64, v8
  s_add_u32 m0, s47, 0
  s_add_u32 s45, s43, 0
  buffer_load_dwordx4 v8, s[8:11], s45 offen offset:0  lds
  s_add_u32 s46, s43, 15360
  buffer_load_dwordx4 v7, s[8:11], s46 offen offset:1024  lds
  s_add_u32 s45, s43, 30720
  buffer_load_dwordx4 v8, s[8:11], s45 offen offset:2048  lds
  s_add_u32 s46, s43, 46080
  buffer_load_dwordx4 v7, s[8:11], s46 offen offset:3072  lds
  s_add_u32 m0, m0, 4096
  s_add_u32 s45, s43, 65536
  buffer_load_dwordx4 v8, s[8:11], s45 offen offset:0  lds
  s_add_u32 s46, s43, 80896
  buffer_load_dwordx4 v7, s[8:11], s46 offen offset:1024  lds
  s_add_u32 s45, s43, 96256
  buffer_load_dwordx4 v8, s[8:11], s45 offen offset:2048  lds
  s_add_u32 s43, s43, 128
  s_add_u32 m0, s47, 32768
  s_add_u32 s45, s43, 0
  buffer_load_dwordx4 v8, s[8:11], s45 offen offset:0  lds
  s_add_u32 s46, s43, 15360
  buffer_load_dwordx4 v7, s[8:11], s46 offen offset:1024  lds
  s_add_u32 s45, s43, 30720
  buffer_load_dwordx4 v8, s[8:11], s45 offen offset:2048  lds
  s_add_u32 s46, s43, 46080
  buffer_load_dwordx4 v7, s[8:11], s46 offen offset:3072  lds
  s_add_u32 m0, m0, 4096
  s_add_u32 s45, s43, 65536
  buffer_load_dwordx4 v8, s[8:11], s45 offen offset:0  lds
  s_add_u32 s46, s43, 80896
  buffer_load_dwordx4 v7, s[8:11], s46 offen offset:1024  lds
  s_add_u32 s45, s43, 96256
  buffer_load_dwordx4 v8, s[8:11], s45 offen offset:2048  lds
  s_add_u32 s43, s43, 128
L_pro2:
  s_lshl_b32 s7, s6, 2
  s_add_u32 s7, s7, s40
  s_lshl_b32 s7, s7, 2
  v_and_b32 v12, 3, v0
  v_add_u32 v12, s7, v12
  v_bfe_u32 v13, v0, 4, 1
  v_lshl_add_u32 v12, v13, 7, v12
  v_mul_u32_u24 v12, 6144, v12
  v_bfe_u32 v13, v0, 2, 2
  v_min_u32 v13, 2, v13
  v_lshl_add_u32 v9, v13, 11, v12
  s_mov_b32 s56, 1179648
  s_and_b32 s7, s5, 3
  s_lshl_b32 s7, s7, 2
  s_add_u32 s7, s7, s40
  s_lshl_b32 s7, s7, 4
  v_and_b32 v11, 15, v0
  v_add_u32 v11, s7, v11
  v_lshlrev_b32 v11, 11, v11
  v_lshrrev_b32 v12, 4, v0
  v_lshl_add_u32 v11, v12, 7, v11
  s_cmp_eq_u32 s41, 0
  s_cselect_b64 vcc, -1, 0
  s_cselect_b32 s56, 512, s56
  v_cndmask_b32 v9, v9, v11, vcc
  v_and_b32 v11, 15, v0
  s_lshl_b32 s7, s40, 6
  v_add_u32 v11, s7, v11
  v_lshlrev_b32 v11, 7, v11
  v_lshrrev_b32 v12, 4, v0
  v_bfe_u32 v13, v0, 1, 3
  v_xor_b32 v13, v12, v13
  v_lshl_add_u32 v2, v13, 4, v11
  v_xor_b32 v3, 64, v2
  v_mov_b32 v244, v2
  v_mov_b32 v245, v3
  v_mul_u32_u24 v11, 3072, v12
  v_bfe_u32 v13, v0, 2, 2
  v_lshl_add_u32 v11, v13, 7, v11
  v_bfe_u32 v14, v0, 1, 1
  s_lshl_b32 s7, s41, 2
  v_add_u32 v14, s7, v14
  v_bfe_u32 v15, v0, 3, 1
  v_lshlrev_b32 v15, 2, v15
  v_xor_b32 v14, v14, v15
  v_bfe_u32 v15, v0, 4, 1
  v_lshlrev_b32 v15, 1, v15
  v_xor_b32 v14, v14, v15
  v_lshl_add_u32 v11, v14, 4, v11
  v_and_b32 v15, 1, v0
  v_lshl_add_u32 v11, v15, 3, v11
  v_add_u32 v4, 98304, v11
  v_xor_b32 v5, 32, v4
  v_mov_b32 v236, 0xdddddddd
  v_and_b32 v11, 15, v0
  v_mov_b32 v12, 0x3f803f80
  v_cmp_eq_u32 vcc, 0, v11
  v_lshlrev_b32 v246, 4, v0
  v_lshlrev_b32 v247, 4, v0
  v_cndmask_b32 v232, v237, v12, vcc
  v_cndmask_b32 v233, v237, v12, vcc
  v_cmp_eq_u32 vcc, 4, v11
  s_nop 1
  v_cndmask_b32 v234, v237, v12, vcc
  v_cndmask_b32 v235, v237, v12, vcc
  v_and_b32 v240, 15, v0
  v_lshlrev_b32 v240, 3, v240
  s_lshl_b32 s7, s6, 3
  v_mov_b32 v241, s7
  s_mov_b32 s42, 0
  s_mov_b32 s50, 32768
  v_mov_b64 v[96:97], 0
  v_mov_b64 v[98:99], 0
  v_mov_b64 v[100:101], 0
  v_mov_b64 v[102:103], 0
  v_mov_b64 v[104:105], 0
  v_mov_b64 v[106:107], 0
  v_mov_b64 v[108:109], 0
  v_mov_b64 v[110:111], 0
  v_mov_b64 v[112:113], 0
  v_mov_b64 v[114:115], 0
  v_mov_b64 v[116:117], 0
  v_mov_b64 v[118:119], 0
  v_mov_b64 v[120:121], 0
  v_mov_b64 v[122:123], 0
  v_mov_b64 v[124:125], 0
  v_mov_b64 v[126:127], 0
  v_mov_b64 v[128:129], 0
  v_mov_b64 v[130:131], 0
  v_mov_b64 v[132:133], 0
  v_mov_b64 v[134:135], 0
  v_mov_b64 v[136:137], 0
  v_mov_b64 v[138:139], 0
  v_mov_b64 v[140:141], 0
  v_mov_b64 v[142:143], 0
  v_mov_b64 v[144:145], 0
  v_mov_b64 v[146:147], 0
  v_mov_b64 v[148:149], 0
  v_mov_b64 v[150:151], 0
  v_mov_b64 v[152:153], 0
  v_mov_b64 v[154:155], 0
  v_mov_b64 v[156:157], 0
  v_mov_b64 v[158:159], 0
  v_mov_b64 v[160:161], 0
  v_mov_b64 v[162:163], 0
  v_mov_b64 v[164:165], 0
  v_mov_b64 v[166:167], 0
  v_mov_b64 v[168:169], 0
  v_mov_b64 v[170:171], 0
  v_mov_b64 v[172:173], 0
  v_mov_b64 v[174:175], 0
  v_mov_b64 v[176:177], 0
  v_mov_b64 v[178:179], 0
  v_mov_b64 v[180:181], 0
  v_mov_b64 v[182:183], 0
  v_mov_b64 v[184:185], 0
  v_mov_b64 v[186:187], 0
  v_mov_b64 v[188:189], 0
  v_mov_b64 v[190:191], 0
  v_mov_b64 v[192:193], 0
  v_mov_b64 v[194:195], 0
  v_mov_b64 v[196:197], 0
  v_mov_b64 v[198:199], 0
  v_mov_b64 v[200:201], 0
  v_mov_b64 v[202:203], 0
  v_mov_b64 v[204:205], 0
  v_mov_b64 v[206:207], 0
  v_mov_b64 v[208:209], 0
  v_mov_b64 v[210:211], 0
  v_mov_b64 v[212:213], 0
  v_mov_b64 v[214:215], 0
  v_mov_b64 v[216:217], 0
  v_mov_b64 v[218:219], 0
  v_mov_b64 v[220:221], 0
  v_mov_b64 v[222:223], 0
  v_mov_b64 v[224:225], 0
  v_mov_b64 v[226:227], 0
  v_mov_b64 v[228:229], 0
  v_mov_b64 v[230:231], 0
  s_cmp_lg_u32 s41, 0
  s_cbranch_scc1 L_g1B_pre
  s_mov_b32 s49, 0
  s_waitcnt vmcnt(8)
  s_barrier
  ds_read_b64_tr_b16 v[48:49], v4 offset:0
  ds_read_b64_tr_b16 v[50:51], v4 offset:512
  ds_read_b128 v[16:19], v2 offset:0
  ds_read_b128 v[20:23], v2 offset:2048
  ds_read_b128 v[24:27], v2 offset:4096
  ds_read_b128 v[28:31], v2 offset:6144
  ds_read_b64_tr_b16 v[52:53], v5 offset:0
  ds_read_b64_tr_b16 v[54:55], v5 offset:512
  ds_read_b64_tr_b16 v[56:57], v4 offset:1024
  ds_read_b64_tr_b16 v[58:59], v4 offset:1536
  ds_read_b64_tr_b16 v[60:61], v5 offset:1024
  ds_read_b64_tr_b16 v[62:63], v5 offset:1536
  ds_read_b64_tr_b16 v[64:65], v4 offset:2048
  ds_read_b64_tr_b16 v[66:67], v4 offset:2560
  ds_read_b64_tr_b16 v[68:69], v5 offset:2048
  ds_read_b64_tr_b16 v[70:71], v5 offset:2560
.p2align 6
L_g1A:
  s_cmp_eq_u32 s42, 7
  s_cselect_b32 s14, 0, s14
  s_waitcnt lgkmcnt(0)
  v_mfma_f32_16x16x32_bf16 v[96:99], v[48:51], v[16:19], v[96:99]
  ds_read_b64_tr_b16 v[72:73], v4 offset:12288
  v_mfma_f32_16x16x32_bf16 v[100:103], v[48:51], v[20:23], v[100:103]
  ds_read_b64_tr_b16 v[74:75], v4 offset:12800
  v_mfma_f32_16x16x32_bf16 v[104:107], v[48:51], v[24:27], v[104:107]
  ds_read_b128 v[32:35], v3 offset:0
  v_mfma_f32_16x16x32_bf16 v[108:111], v[48:51], v[28:31], v[108:111]
  ds_read_b128 v[36:39], v3 offset:2048
  v_mfma_f32_16x16x32_bf16 v[124:127], v[52:55], v[28:31], v[124:127]
  ds_read_b128 v[40:43], v3 offset:4096
  v_mfma_f32_16x16x32_bf16 v[120:123], v[52:55], v[24:27], v[120:123]
  ds_read_b128 v[44:47], v3 offset:6144
  v_mfma_f32_16x16x32_bf16 v[116:119], v[52:55], v[20:23], v[116:119]
  ds_read_b64_tr_b16 v[76:77], v5 offset:12288
  v_mfma_f32_16x16x32_bf16 v[112:115], v[52:55], v[16:19], v[112:115]
  ds_read_b64_tr_b16 v[78:79], v5 offset:12800
  v_mfma_f32_16x16x32_bf16 v[128:131], v[56:59], v[16:19], v[128:131]
  ds_read_b64_tr_b16 v[80:81], v4 offset:13312
  v_mfma_f32_16x16x32_bf16 v[132:135], v[56:59], v[20:23], v[132:135]
  ds_read_b64_tr_b16 v[82:83], v4 offset:13824
  v_mfma_f32_16x16x32_bf16 v[136:139], v[56:59], v[24:27], v[136:139]
  ds_read_b64_tr_b16 v[84:85], v5 offset:13312
  v_mfma_f32_16x16x32_bf16 v[140:143], v[56:59], v[28:31], v[140:143]
  ds_read_b64_tr_b16 v[86:87], v5 offset:13824
  v_mfma_f32_16x16x32_bf16 v[156:159], v[60:63], v[28:31], v[156:159]
  ds_read_b64_tr_b16 v[88:89], v4 offset:14336
  v_mfma_f32_16x16x32_bf16 v[152:155], v[60:63], v[24:27], v[152:155]
  ds_read_b64_tr_b16 v[90:91], v4 offset:14848
  v_mfma_f32_16x16x32_bf16 v[148:151], v[60:63], v[20:23], v[148:151]
  ds_read_b64_tr_b16 v[92:93], v5 offset:14336
  v_mfma_f32_16x16x32_bf16 v[144:147], v[60:63], v[16:19], v[144:147]
  ds_read_b64_tr_b16 v[94:95], v5 offset:14848
  v_mfma_f32_16x16x32_bf16 v[160:163], v[16:19], v[64:67], v[160:163]
  v_mfma_f32_16x16x32_bf16 v[176:179], v[16:19], v[68:71], v[176:179]
  v_mfma_f32_16x16x32_bf16 v[180:183], v[20:23], v[68:71], v[180:183]
  v_mfma_f32_16x16x32_bf16 v[164:167], v[20:23], v[64:67], v[164:167]
  v_mfma_f32_16x16x32_bf16 v[168:171], v[24:27], v[64:67], v[168:171]
  v_mfma_f32_16x16x32_bf16 v[184:187], v[24:27], v[68:71], v[184:187]
  v_mfma_f32_16x16x32_bf16 v[188:191], v[28:31], v[68:71], v[188:191]
  v_mfma_f32_16x16x32_bf16 v[172:175], v[28:31], v[64:67], v[172:175]
  v_add_u32 v2, s50, v244
  s_waitcnt vmcnt(1) lgkmcnt(0)
  s_barrier
  s_add_u32 m0, s48, 0
  s_nop 0
  buffer_load_dwordx4 v6, s[12:15], s44 offen offset:0  lds
  s_add_u32 s46, s44, 1024
  buffer_load_dwordx4 v6, s[12:15], s46 offen offset:1024  lds
  s_add_u32 s45, s44, 2048
  buffer_load_dwordx4 v6, s[12:15], s45 offen offset:2048  lds
  s_add_u32 m0, s48, 3072
  s_nop 0
  buffer_load_dwordx4 v7, s[12:15], s44 offen offset:0  lds
  s_add_u32 s46, s44, 1024
  buffer_load_dwordx4 v7, s[12:15], s46 offen offset:1024  lds
  s_add_u32 s45, s44, 2048
  buffer_load_dwordx4 v7, s[12:15], s45 offen offset:2048  lds
  s_add_u32 s44, s44, 393216
  s_add_u32 m0, s47, s49
  s_nop 0
  buffer_load_dwordx4 v8, s[8:11], s43 offen  lds
  s_add_u32 s43, s43, 128
  v_mfma_f32_16x16x32_bf16 v[96:99], v[72:75], v[32:35], v[96:99]
  ds_read_b64_tr_b16 v[48:49], v4 offset:24576
  v_mfma_f32_16x16x32_bf16 v[100:103], v[72:75], v[36:39], v[100:103]
  ds_read_b64_tr_b16 v[50:51], v4 offset:25088
  v_mfma_f32_16x16x32_bf16 v[104:107], v[72:75], v[40:43], v[104:107]
  ds_read_b128 v[16:19], v2 offset:0
  v_mfma_f32_16x16x32_bf16 v[108:111], v[72:75], v[44:47], v[108:111]
  v_mfma_f32_16x16x32_bf16 v[124:127], v[76:79], v[44:47], v[124:127]
  ds_read_b128 v[20:23], v2 offset:2048
  v_mfma_f32_16x16x32_bf16 v[120:123], v[76:79], v[40:43], v[120:123]
  ds_read_b128 v[24:27], v2 offset:4096
  v_mfma_f32_16x16x32_bf16 v[116:119], v[76:79], v[36:39], v[116:119]
  v_mfma_f32_16x16x32_bf16 v[112:115], v[76:79], v[32:35], v[112:115]
  ds_read_b128 v[28:31], v2 offset:6144
  v_mfma_f32_16x16x32_bf16 v[128:131], v[80:83], v[32:35], v[128:131]
  ds_read_b64_tr_b16 v[52:53], v5 offset:24576
  v_mfma_f32_16x16x32_bf16 v[132:135], v[80:83], v[36:39], v[132:135]
  ds_read_b64_tr_b16 v[54:55], v5 offset:25088
  v_mfma_f32_16x16x32_bf16 v[136:139], v[80:83], v[40:43], v[136:139]
  v_mfma_f32_16x16x32_bf16 v[140:143], v[80:83], v[44:47], v[140:143]
  ds_read_b64_tr_b16 v[56:57], v4 offset:25600
  v_mfma_f32_16x16x32_bf16 v[156:159], v[84:87], v[44:47], v[156:159]
  ds_read_b64_tr_b16 v[58:59], v4 offset:26112
  v_mfma_f32_16x16x32_bf16 v[152:155], v[84:87], v[40:43], v[152:155]
  v_mfma_f32_16x16x32_bf16 v[148:151], v[84:87], v[36:39], v[148:151]
  ds_read_b64_tr_b16 v[60:61], v5 offset:25600
  v_mfma_f32_16x16x32_bf16 v[144:147], v[84:87], v[32:35], v[144:147]
  ds_read_b64_tr_b16 v[62:63], v5 offset:26112
  v_mfma_f32_16x16x32_bf16 v[160:163], v[32:35], v[88:91], v[160:163]
  ds_read_b64_tr_b16 v[64:65], v4 offset:26624
  v_mfma_f32_16x16x32_bf16 v[176:179], v[32:35], v[92:95], v[176:179]
  v_mfma_f32_16x16x32_bf16 v[180:183], v[36:39], v[92:95], v[180:183]
  ds_read_b64_tr_b16 v[66:67], v4 offset:27136
  v_mfma_f32_16x16x32_bf16 v[164:167], v[36:39], v[88:91], v[164:167]
  ds_read_b64_tr_b16 v[68:69], v5 offset:26624
  v_mfma_f32_16x16x32_bf16 v[168:171], v[40:43], v[88:91], v[168:171]
  v_add_u32 v3, s50, v245
  s_mov_b32 s49, s50
  s_add_u32 s50, s50, 32768
  s_cmp_eq_u32 s50, 98304
  s_cselect_b32 s50, 0, s50
  v_mfma_f32_16x16x32_bf16 v[184:187], v[40:43], v[92:95], v[184:187]
  ds_read_b64_tr_b16 v[70:71], v5 offset:27136
  v_mfma_f32_16x16x32_bf16 v[188:191], v[44:47], v[92:95], v[188:191]
  v_mfma_f32_16x16x32_bf16 v[172:175], v[44:47], v[88:91], v[172:175]
  s_waitcnt lgkmcnt(0)
  v_mfma_f32_16x16x32_bf16 v[96:99], v[48:51], v[16:19], v[96:99]
  ds_read_b64_tr_b16 v[72:73], v4 offset:36864
  v_mfma_f32_16x16x32_bf16 v[100:103], v[48:51], v[20:23], v[100:103]
  ds_read_b64_tr_b16 v[74:75], v4 offset:37376
  v_mfma_f32_16x16x32_bf16 v[104:107], v[48:51], v[24:27], v[104:107]
  ds_read_b128 v[32:35], v3 offset:0
  v_mfma_f32_16x16x32_bf16 v[108:111], v[48:51], v[28:31], v[108:111]
  ds_read_b128 v[36:39], v3 offset:2048
  v_mfma_f32_16x16x32_bf16 v[124:127], v[52:55], v[28:31], v[124:127]
  ds_read_b128 v[40:43], v3 offset:4096
  v_mfma_f32_16x16x32_bf16 v[120:123], v[52:55], v[24:27], v[120:123]
  ds_read_b128 v[44:47], v3 offset:6144
  v_mfma_f32_16x16x32_bf16 v[116:119], v[52:55], v[20:23], v[116:119]
  ds_read_b64_tr_b16 v[76:77], v5 offset:36864
  v_mfma_f32_16x16x32_bf16 v[112:115], v[52:55], v[16:19], v[112:115]
  ds_read_b64_tr_b16 v[78:79], v5 offset:37376
  v_mfma_f32_16x16x32_bf16 v[128:131], v[56:59], v[16:19], v[128:131]
  ds_read_b64_tr_b16 v[80:81], v4 offset:37888
  v_mfma_f32_16x16x32_bf16 v[132:135], v[56:59], v[20:23], v[132:135]
  ds_read_b64_tr_b16 v[82:83], v4 offset:38400
  v_mfma_f32_16x16x32_bf16 v[136:139], v[56:59], v[24:27], v[136:139]
  ds_read_b64_tr_b16 v[84:85], v5 offset:37888
  v_mfma_f32_16x16x32_bf16 v[140:143], v[56:59], v[28:31], v[140:143]
  ds_read_b64_tr_b16 v[86:87], v5 offset:38400
  v_mfma_f32_16x16x32_bf16 v[156:159], v[60:63], v[28:31], v[156:159]
  ds_read_b64_tr_b16 v[88:89], v4 offset:38912
  v_mfma_f32_16x16x32_bf16 v[152:155], v[60:63], v[24:27], v[152:155]
  ds_read_b64_tr_b16 v[90:91], v4 offset:39424
  v_mfma_f32_16x16x32_bf16 v[148:151], v[60:63], v[20:23], v[148:151]
  ds_read_b64_tr_b16 v[92:93], v5 offset:38912
  v_mfma_f32_16x16x32_bf16 v[144:147], v[60:63], v[16:19], v[144:147]
  ds_read_b64_tr_b16 v[94:95], v5 offset:39424
  v_mfma_f32_16x16x32_bf16 v[160:163], v[16:19], v[64:67], v[160:163]
  v_mfma_f32_16x16x32_bf16 v[176:179], v[16:19], v[68:71], v[176:179]
  v_mfma_f32_16x16x32_bf16 v[180:183], v[20:23], v[68:71], v[180:183]
  v_mfma_f32_16x16x32_bf16 v[164:167], v[20:23], v[64:67], v[164:167]
  v_mfma_f32_16x16x32_bf16 v[168:171], v[24:27], v[64:67], v[168:171]
  v_mfma_f32_16x16x32_bf16 v[184:187], v[24:27], v[68:71], v[184:187]
  v_mfma_f32_16x16x32_bf16 v[188:191], v[28:31], v[68:71], v[188:191]
  v_mfma_f32_16x16x32_bf16 v[172:175], v[28:31], v[64:67], v[172:175]
  s_cmp_ge_u32 s42, 6
  s_cselect_b32 s10, 0, s10
  v_add_u32 v2, s50, v244
  s_waitcnt vmcnt(1) lgkmcnt(0)
  s_barrier
  s_cmp_eq_u32 s42, 7
  s_cbranch_scc1 L_g1A_last
  s_add_u32 m0, s48, 24576
  s_nop 0
  buffer_load_dwordx4 v6, s[12:15], s44 offen offset:0  lds
  s_add_u32 s46, s44, 1024
  buffer_load_dwordx4 v6, s[12:15], s46 offen offset:1024  lds
  s_add_u32 s45, s44, 2048
  buffer_load_dwordx4 v6, s[12:15], s45 offen offset:2048  lds
  s_add_u32 m0, s48, 27648
  s_nop 0
  buffer_load_dwordx4 v7, s[12:15], s44 offen offset:0  lds
  s_add_u32 s46, s44, 1024
  buffer_load_dwordx4 v7, s[12:15], s46 offen offset:1024  lds
  s_add_u32 s45, s44, 2048
  buffer_load_dwordx4 v7, s[12:15], s45 offen offset:2048  lds
  s_add_u32 s44, s44, 393216
  s_add_u32 m0, s47, s49
  s_nop 0
  buffer_load_dwordx4 v8, s[8:11], s43 offen  lds
  s_add_u32 s43, s43, 128
  v_mfma_f32_16x16x32_bf16 v[96:99], v[72:75], v[32:35], v[96:99]
  ds_read_b64_tr_b16 v[48:49], v4 offset:0
  v_mfma_f32_16x16x32_bf16 v[100:103], v[72:75], v[36:39], v[100:103]
  ds_read_b64_tr_b16 v[50:51], v4 offset:512
  v_mfma_f32_16x16x32_bf16 v[104:107], v[72:75], v[40:43], v[104:107]
  ds_read_b128 v[16:19], v2 offset:0
  v_mfma_f32_16x16x32_bf16 v[108:111], v[72:75], v[44:47], v[108:111]
  v_mfma_f32_16x16x32_bf16 v[124:127], v[76:79], v[44:47], v[124:127]
  ds_read_b128 v[20:23], v2 offset:2048
  v_mfma_f32_16x16x32_bf16 v[120:123], v[76:79], v[40:43], v[120:123]
  ds_read_b128 v[24:27], v2 offset:4096
  v_mfma_f32_16x16x32_bf16 v[116:119], v[76:79], v[36:39], v[116:119]
  v_mfma_f32_16x16x32_bf16 v[112:115], v[76:79], v[32:35], v[112:115]
  ds_read_b128 v[28:31], v2 offset:6144
  v_mfma_f32_16x16x32_bf16 v[128:131], v[80:83], v[32:35], v[128:131]
  ds_read_b64_tr_b16 v[52:53], v5 offset:0
  v_mfma_f32_16x16x32_bf16 v[132:135], v[80:83], v[36:39], v[132:135]
  ds_read_b64_tr_b16 v[54:55], v5 offset:512
  v_mfma_f32_16x16x32_bf16 v[136:139], v[80:83], v[40:43], v[136:139]
  v_mfma_f32_16x16x32_bf16 v[140:143], v[80:83], v[44:47], v[140:143]
  ds_read_b64_tr_b16 v[56:57], v4 offset:1024
  v_mfma_f32_16x16x32_bf16 v[156:159], v[84:87], v[44:47], v[156:159]
  ds_read_b64_tr_b16 v[58:59], v4 offset:1536
  v_mfma_f32_16x16x32_bf16 v[152:155], v[84:87], v[40:43], v[152:155]
  v_mfma_f32_16x16x32_bf16 v[148:151], v[84:87], v[36:39], v[148:151]
  ds_read_b64_tr_b16 v[60:61], v5 offset:1024
  v_mfma_f32_16x16x32_bf16 v[144:147], v[84:87], v[32:35], v[144:147]
  ds_read_b64_tr_b16 v[62:63], v5 offset:1536
  v_mfma_f32_16x16x32_bf16 v[160:163], v[32:35], v[88:91], v[160:163]
  ds_read_b64_tr_b16 v[64:65], v4 offset:2048
  v_mfma_f32_16x16x32_bf16 v[176:179], v[32:35], v[92:95], v[176:179]
  v_mfma_f32_16x16x32_bf16 v[180:183], v[36:39], v[92:95], v[180:183]
  ds_read_b64_tr_b16 v[66:67], v4 offset:2560
  v_mfma_f32_16x16x32_bf16 v[164:167], v[36:39], v[88:91], v[164:167]
  ds_read_b64_tr_b16 v[68:69], v5 offset:2048
  v_mfma_f32_16x16x32_bf16 v[168:171], v[40:43], v[88:91], v[168:171]
  v_add_u32 v3, s50, v245
  s_mov_b32 s49, s50
  s_add_u32 s50, s50, 32768
  s_cmp_eq_u32 s50, 98304
  s_cselect_b32 s50, 0, s50
  v_mfma_f32_16x16x32_bf16 v[184:187], v[40:43], v[92:95], v[184:187]
  ds_read_b64_tr_b16 v[70:71], v5 offset:2560
  v_mfma_f32_16x16x32_bf16 v[188:191], v[44:47], v[92:95], v[188:191]
  v_mfma_f32_16x16x32_bf16 v[172:175], v[44:47], v[88:91], v[172:175]
  s_add_u32 s42, s42, 1
  s_branch L_g1A
L_g1B_pre:
  s_mov_b32 s49, 65536
  s_waitcnt vmcnt(7)
  s_barrier
  ds_read_b64_tr_b16 v[48:49], v4 offset:0
  ds_read_b64_tr_b16 v[50:51], v4 offset:512
  ds_read_b128 v[16:19], v2 offset:0
  ds_read_b128 v[20:23], v2 offset:2048
  ds_read_b128 v[24:27], v2 offset:4096
  ds_read_b128 v[28:31], v2 offset:6144
  ds_read_b64_tr_b16 v[52:53], v5 offset:0
  ds_read_b64_tr_b16 v[54:55], v5 offset:512
  ds_read_b64_tr_b16 v[56:57], v4 offset:1024
  ds_read_b64_tr_b16 v[58:59], v4 offset:1536
  ds_read_b64_tr_b16 v[60:61], v5 offset:1024
  ds_read_b64_tr_b16 v[62:63], v5 offset:1536
  ds_read_b64_tr_b16 v[64:65], v4 offset:2048
  ds_read_b64_tr_b16 v[66:67], v4 offset:2560
  ds_read_b64_tr_b16 v[68:69], v5 offset:2048
  ds_read_b64_tr_b16 v[70:71], v5 offset:2560
.p2align 6
L_g1B:
  s_cmp_eq_u32 s42, 7
  s_cselect_b32 s10, 0, s10
  s_add_u32 m0, s47, s49
  s_add_u32 s45, s43, 0
  buffer_load_dwordx4 v8, s[8:11], s45 offen offset:0  lds
  s_add_u32 s46, s43, 15360
  buffer_load_dwordx4 v7, s[8:11], s46 offen offset:1024  lds
  s_add_u32 s45, s43, 30720
  buffer_load_dwordx4 v8, s[8:11], s45 offen offset:2048  lds
  s_add_u32 s46, s43, 46080
  buffer_load_dwordx4 v7, s[8:11], s46 offen offset:3072  lds
  s_add_u32 m0, m0, 4096
  s_add_u32 s45, s43, 65536
  buffer_load_dwordx4 v8, s[8:11], s45 offen offset:0  lds
  s_add_u32 s46, s43, 80896
  buffer_load_dwordx4 v7, s[8:11], s46 offen offset:1024  lds
  s_add_u32 s45, s43, 96256
  buffer_load_dwordx4 v8, s[8:11], s45 offen offset:2048  lds
  s_add_u32 s43, s43, 128
  buffer_load_dword v10, v9, s[12:15], s56 offen
  s_add_u32 s56, s56, 1572864
  s_waitcnt lgkmcnt(0)
  v_mfma_f32_16x16x32_bf16 v[96:99], v[48:51], v[16:19], v[96:99]
  ds_read_b64_tr_b16 v[72:73], v4 offset:12288
  v_mfma_f32_16x16x32_bf16 v[100:103], v[48:51], v[20:23], v[100:103]
  ds_read_b64_tr_b16 v[74:75], v4 offset:12800
  v_mfma_f32_16x16x32_bf16 v[104:107], v[48:51], v[24:27], v[104:107]
  ds_read_b128 v[32:35], v3 offset:0
  v_mfma_f32_16x16x32_bf16 v[108:111], v[48:51], v[28:31], v[108:111]
  ds_read_b128 v[36:39], v3 offset:2048
  v_mfma_f32_16x16x32_bf16 v[124:127], v[52:55], v[28:31], v[124:127]
  ds_read_b128 v[40:43], v3 offset:4096
  v_mfma_f32_16x16x32_bf16 v[120:123], v[52:55], v[24:27], v[120:123]
  ds_read_b128 v[44:47], v3 offset:6144
  v_mfma_f32_16x16x32_bf16 v[116:119], v[52:55], v[20:23], v[116:119]
  ds_read_b64_tr_b16 v[76:77], v5 offset:12288
  v_mfma_f32_16x16x32_bf16 v[112:115], v[52:55], v[16:19], v[112:115]
  ds_read_b64_tr_b16 v[78:79], v5 offset:12800
  v_mfma_f32_16x16x32_bf16 v[128:131], v[56:59], v[16:19], v[128:131]
  ds_read_b64_tr_b16 v[80:81], v4 offset:13312
  v_mfma_f32_16x16x32_bf16 v[132:135], v[56:59], v[20:23], v[132:135]
  ds_read_b64_tr_b16 v[82:83], v4 offset:13824
  v_mfma_f32_16x16x32_bf16 v[136:139], v[56:59], v[24:27], v[136:139]
  ds_read_b64_tr_b16 v[84:85], v5 offset:13312
  v_mfma_f32_16x16x32_bf16 v[140:143], v[56:59], v[28:31], v[140:143]
  ds_read_b64_tr_b16 v[86:87], v5 offset:13824
  v_mfma_f32_16x16x32_bf16 v[156:159], v[60:63], v[28:31], v[156:159]
  ds_read_b64_tr_b16 v[88:89], v4 offset:14336
  v_mfma_f32_16x16x32_bf16 v[152:155], v[60:63], v[24:27], v[152:155]
  ds_read_b64_tr_b16 v[90:91], v4 offset:14848
  v_mfma_f32_16x16x32_bf16 v[148:151], v[60:63], v[20:23], v[148:151]
  ds_read_b64_tr_b16 v[92:93], v5 offset:14336
  v_mfma_f32_16x16x32_bf16 v[144:147], v[60:63], v[16:19], v[144:147]
  ds_read_b64_tr_b16 v[94:95], v5 offset:14848
  v_mfma_f32_16x16x32_bf16 v[160:163], v[16:19], v[64:67], v[160:163]
  v_mfma_f32_16x16x32_bf16 v[176:179], v[16:19], v[68:71], v[176:179]
  v_mfma_f32_16x16x32_bf16 v[180:183], v[20:23], v[68:71], v[180:183]
  v_mfma_f32_16x16x32_bf16 v[164:167], v[20:23], v[64:67], v[164:167]
  v_mfma_f32_16x16x32_bf16 v[168:171], v[24:27], v[64:67], v[168:171]
  v_mfma_f32_16x16x32_bf16 v[184:187], v[24:27], v[68:71], v[184:187]
  v_mfma_f32_16x16x32_bf16 v[188:191], v[28:31], v[68:71], v[188:191]
  v_mfma_f32_16x16x32_bf16 v[172:175], v[28:31], v[64:67], v[172:175]
  v_add_u32 v2, s50, v244
  s_waitcnt vmcnt(8) lgkmcnt(0)
  s_barrier
  v_mfma_f32_16x16x32_bf16 v[96:99], v[72:75], v[32:35], v[96:99]
  ds_read_b64_tr_b16 v[48:49], v4 offset:24576
  v_mfma_f32_16x16x32_bf16 v[100:103], v[72:75], v[36:39], v[100:103]
  ds_read_b64_tr_b16 v[50:51], v4 offset:25088
  v_mfma_f32_16x16x32_bf16 v[104:107], v[72:75], v[40:43], v[104:107]
  ds_read_b128 v[16:19], v2 offset:0
  v_mfma_f32_16x16x32_bf16 v[108:111], v[72:75], v[44:47], v[108:111]
  v_mfma_f32_16x16x32_bf16 v[124:127], v[76:79], v[44:47], v[124:127]
  ds_read_b128 v[20:23], v2 offset:2048
  v_mfma_f32_16x16x32_bf16 v[120:123], v[76:79], v[40:43], v[120:123]
  ds_read_b128 v[24:27], v2 offset:4096
  v_mfma_f32_16x16x32_bf16 v[116:119], v[76:79], v[36:39], v[116:119]
  v_mfma_f32_16x16x32_bf16 v[112:115], v[76:79], v[32:35], v[112:115]
  ds_read_b128 v[28:31], v2 offset:6144
  v_mfma_f32_16x16x32_bf16 v[128:131], v[80:83], v[32:35], v[128:131]
  ds_read_b64_tr_b16 v[52:53], v5 offset:24576
  v_mfma_f32_16x16x32_bf16 v[132:135], v[80:83], v[36:39], v[132:135]
  ds_read_b64_tr_b16 v[54:55], v5 offset:25088
  v_mfma_f32_16x16x32_bf16 v[136:139], v[80:83], v[40:43], v[136:139]
  v_mfma_f32_16x16x32_bf16 v[140:143], v[80:83], v[44:47], v[140:143]
  ds_read_b64_tr_b16 v[56:57], v4 offset:25600
  v_mfma_f32_16x16x32_bf16 v[156:159], v[84:87], v[44:47], v[156:159]
  ds_read_b64_tr_b16 v[58:59], v4 offset:26112
  v_mfma_f32_16x16x32_bf16 v[152:155], v[84:87], v[40:43], v[152:155]
  v_mfma_f32_16x16x32_bf16 v[148:151], v[84:87], v[36:39], v[148:151]
  ds_read_b64_tr_b16 v[60:61], v5 offset:25600
  v_mfma_f32_16x16x32_bf16 v[144:147], v[84:87], v[32:35], v[144:147]
  ds_read_b64_tr_b16 v[62:63], v5 offset:26112
  v_mfma_f32_16x16x32_bf16 v[160:163], v[32:35], v[88:91], v[160:163]
  ds_read_b64_tr_b16 v[64:65], v4 offset:26624
  v_mfma_f32_16x16x32_bf16 v[176:179], v[32:35], v[92:95], v[176:179]
  v_mfma_f32_16x16x32_bf16 v[180:183], v[36:39], v[92:95], v[180:183]
  ds_read_b64_tr_b16 v[66:67], v4 offset:27136
  v_mfma_f32_16x16x32_bf16 v[164:167], v[36:39], v[88:91], v[164:167]
  ds_read_b64_tr_b16 v[68:69], v5 offset:26624
  v_mfma_f32_16x16x32_bf16 v[168:171], v[40:43], v[88:91], v[168:171]
  v_add_u32 v3, s50, v245
  s_add_u32 s49, s49, 32768
  s_cmp_eq_u32 s49, 98304
  s_cselect_b32 s49, 0, s49
  s_add_u32 s50, s50, 32768
  s_cmp_eq_u32 s50, 98304
  s_cselect_b32 s50, 0, s50
  v_mfma_f32_16x16x32_bf16 v[184:187], v[40:43], v[92:95], v[184:187]
  ds_read_b64_tr_b16 v[70:71], v5 offset:27136
  v_mfma_f32_16x16x32_bf16 v[188:191], v[44:47], v[92:95], v[188:191]
  v_mfma_f32_16x16x32_bf16 v[172:175], v[44:47], v[88:91], v[172:175]
  s_add_u32 m0, s47, s49
  s_add_u32 s45, s43, 0
  buffer_load_dwordx4 v8, s[8:11], s45 offen offset:0  lds
  s_add_u32 s46, s43, 15360
  buffer_load_dwordx4 v7, s[8:11], s46 offen offset:1024  lds
  s_add_u32 s45, s43, 30720
  buffer_load_dwordx4 v8, s[8:11], s45 offen offset:2048  lds
  s_add_u32 s46, s43, 46080
  buffer_load_dwordx4 v7, s[8:11], s46 offen offset:3072  lds
  s_add_u32 m0, m0, 4096
  s_add_u32 s45, s43, 65536
  buffer_load_dwordx4 v8, s[8:11], s45 offen offset:0  lds
  s_add_u32 s46, s43, 80896
  buffer_load_dwordx4 v7, s[8:11], s46 offen offset:1024  lds
  s_add_u32 s45, s43, 96256
  buffer_load_dwordx4 v8, s[8:11], s45 offen offset:2048  lds
  s_add_u32 s43, s43, 128
  s_waitcnt lgkmcnt(0)
  v_mfma_f32_16x16x32_bf16 v[96:99], v[48:51], v[16:19], v[96:99]
  ds_read_b64_tr_b16 v[72:73], v4 offset:36864
  v_mfma_f32_16x16x32_bf16 v[100:103], v[48:51], v[20:23], v[100:103]
  ds_read_b64_tr_b16 v[74:75], v4 offset:37376
  v_mfma_f32_16x16x32_bf16 v[104:107], v[48:51], v[24:27], v[104:107]
  ds_read_b128 v[32:35], v3 offset:0
  v_mfma_f32_16x16x32_bf16 v[108:111], v[48:51], v[28:31], v[108:111]
  ds_read_b128 v[36:39], v3 offset:2048
  v_mfma_f32_16x16x32_bf16 v[124:127], v[52:55], v[28:31], v[124:127]
  ds_read_b128 v[40:43], v3 offset:4096
  v_mfma_f32_16x16x32_bf16 v[120:123], v[52:55], v[24:27], v[120:123]
  ds_read_b128 v[44:47], v3 offset:6144
  v_mfma_f32_16x16x32_bf16 v[116:119], v[52:55], v[20:23], v[116:119]
  ds_read_b64_tr_b16 v[76:77], v5 offset:36864
  v_mfma_f32_16x16x32_bf16 v[112:115], v[52:55], v[16:19], v[112:115]
  ds_read_b64_tr_b16 v[78:79], v5 offset:37376
  v_mfma_f32_16x16x32_bf16 v[128:131], v[56:59], v[16:19], v[128:131]
  ds_read_b64_tr_b16 v[80:81], v4 offset:37888
  v_mfma_f32_16x16x32_bf16 v[132:135], v[56:59], v[20:23], v[132:135]
  ds_read_b64_tr_b16 v[82:83], v4 offset:38400
  v_mfma_f32_16x16x32_bf16 v[136:139], v[56:59], v[24:27], v[136:139]
  ds_read_b64_tr_b16 v[84:85], v5 offset:37888
  v_mfma_f32_16x16x32_bf16 v[140:143], v[56:59], v[28:31], v[140:143]
  ds_read_b64_tr_b16 v[86:87], v5 offset:38400
  v_mfma_f32_16x16x32_bf16 v[156:159], v[60:63], v[28:31], v[156:159]
  ds_read_b64_tr_b16 v[88:89], v4 offset:38912
  v_mfma_f32_16x16x32_bf16 v[152:155], v[60:63], v[24:27], v[152:155]
  ds_read_b64_tr_b16 v[90:91], v4 offset:39424
  v_mfma_f32_16x16x32_bf16 v[148:151], v[60:63], v[20:23], v[148:151]
  ds_read_b64_tr_b16 v[92:93], v5 offset:38912
  v_mfma_f32_16x16x32_bf16 v[144:147], v[60:63], v[16:19], v[144:147]
  ds_read_b64_tr_b16 v[94:95], v5 offset:39424
  v_mfma_f32_16x16x32_bf16 v[160:163], v[16:19], v[64:67], v[160:163]
  v_mfma_f32_16x16x32_bf16 v[176:179], v[16:19], v[68:71], v[176:179]
  v_mfma_f32_16x16x32_bf16 v[180:183], v[20:23], v[68:71], v[180:183]
  v_mfma_f32_16x16x32_bf16 v[164:167], v[20:23], v[64:67], v[164:167]
  v_mfma_f32_16x16x32_bf16 v[168:171], v[24:27], v[64:67], v[168:171]
  v_mfma_f32_16x16x32_bf16 v[184:187], v[24:27], v[68:71], v[184:187]
  v_mfma_f32_16x16x32_bf16 v[188:191], v[28:31], v[68:71], v[188:191]
  v_mfma_f32_16x16x32_bf16 v[172:175], v[28:31], v[64:67], v[172:175]
  v_add_u32 v2, s50, v244
  s_waitcnt vmcnt(7) lgkmcnt(0)
  s_barrier
  s_cmp_eq_u32 s42, 7
  s_cbranch_scc1 L_g1A_last
  v_mfma_f32_16x16x32_bf16 v[96:99], v[72:75], v[32:35], v[96:99]
  ds_read_b64_tr_b16 v[48:49], v4 offset:0
  v_mfma_f32_16x16x32_bf16 v[100:103], v[72:75], v[36:39], v[100:103]
  ds_read_b64_tr_b16 v[50:51], v4 offset:512
  v_mfma_f32_16x16x32_bf16 v[104:107], v[72:75], v[40:43], v[104:107]
  ds_read_b128 v[16:19], v2 offset:0
  v_mfma_f32_16x16x32_bf16 v[108:111], v[72:75], v[44:47], v[108:111]
  v_mfma_f32_16x16x32_bf16 v[124:127], v[76:79], v[44:47], v[124:127]
  ds_read_b128 v[20:23], v2 offset:2048
  v_mfma_f32_16x16x32_bf16 v[120:123], v[76:79], v[40:43], v[120:123]
  ds_read_b128 v[24:27], v2 offset:4096
  v_mfma_f32_16x16x32_bf16 v[116:119], v[76:79], v[36:39], v[116:119]
  v_mfma_f32_16x16x32_bf16 v[112:115], v[76:79], v[32:35], v[112:115]
  ds_read_b128 v[28:31], v2 offset:6144
  v_mfma_f32_16x16x32_bf16 v[128:131], v[80:83], v[32:35], v[128:131]
  ds_read_b64_tr_b16 v[52:53], v5 offset:0
  v_mfma_f32_16x16x32_bf16 v[132:135], v[80:83], v[36:39], v[132:135]
  ds_read_b64_tr_b16 v[54:55], v5 offset:512
  v_mfma_f32_16x16x32_bf16 v[136:139], v[80:83], v[40:43], v[136:139]
  v_mfma_f32_16x16x32_bf16 v[140:143], v[80:83], v[44:47], v[140:143]
  ds_read_b64_tr_b16 v[56:57], v4 offset:1024
  v_mfma_f32_16x16x32_bf16 v[156:159], v[84:87], v[44:47], v[156:159]
  ds_read_b64_tr_b16 v[58:59], v4 offset:1536
  v_mfma_f32_16x16x32_bf16 v[152:155], v[84:87], v[40:43], v[152:155]
  v_mfma_f32_16x16x32_bf16 v[148:151], v[84:87], v[36:39], v[148:151]
  ds_read_b64_tr_b16 v[60:61], v5 offset:1024
  v_mfma_f32_16x16x32_bf16 v[144:147], v[84:87], v[32:35], v[144:147]
  ds_read_b64_tr_b16 v[62:63], v5 offset:1536
  v_mfma_f32_16x16x32_bf16 v[160:163], v[32:35], v[88:91], v[160:163]
  ds_read_b64_tr_b16 v[64:65], v4 offset:2048
  v_mfma_f32_16x16x32_bf16 v[176:179], v[32:35], v[92:95], v[176:179]
  v_mfma_f32_16x16x32_bf16 v[180:183], v[36:39], v[92:95], v[180:183]
  ds_read_b64_tr_b16 v[66:67], v4 offset:2560
  v_mfma_f32_16x16x32_bf16 v[164:167], v[36:39], v[88:91], v[164:167]
  ds_read_b64_tr_b16 v[68:69], v5 offset:2048
  v_mfma_f32_16x16x32_bf16 v[168:171], v[40:43], v[88:91], v[168:171]
  v_add_u32 v3, s50, v245
  s_add_u32 s49, s49, 32768
  s_cmp_eq_u32 s49, 98304
  s_cselect_b32 s49, 0, s49
  s_add_u32 s50, s50, 32768
  s_cmp_eq_u32 s50, 98304
  s_cselect_b32 s50, 0, s50
  v_mfma_f32_16x16x32_bf16 v[184:187], v[40:43], v[92:95], v[184:187]
  ds_read_b64_tr_b16 v[70:71], v5 offset:2560
  v_mfma_f32_16x16x32_bf16 v[188:191], v[44:47], v[92:95], v[188:191]
  v_mfma_f32_16x16x32_bf16 v[172:175], v[44:47], v[88:91], v[172:175]
  s_add_u32 s42, s42, 1
  s_branch L_g1B
L_g1A_last:
  v_mfma_f32_16x16x32_bf16 v[128:131], v[80:83], v[32:35], v[128:131]
  s_mov_b32 s36, s32
  s_mov_b32 s37, s33
  s_mov_b32 s38, 26214400
  v_mfma_f32_16x16x32_bf16 v[132:135], v[80:83], v[36:39], v[132:135]
  s_mov_b32 s52, s30
  s_mov_b32 s53, s31
  s_mov_b32 s54, 256
  v_mfma_f32_16x16x32_bf16 v[144:147], v[84:87], v[32:35], v[144:147]
  buffer_load_dwordx2 v[238:239], v237, s[52:55], 0 offen sc1
  s_lshl_b32 s7, s4, 4
  s_add_u32 s7, s7, s5
  v_mfma_f32_16x16x32_bf16 v[148:151], v[84:87], v[36:39], v[148:151]
  s_lshl_b32 s49, s7, 3
  s_lshl_b32 s7, s7, 1
  s_add_u32 s7, s7, s41
  v_mfma_f32_16x16x32_bf16 v[160:163], v[32:35], v[88:91], v[160:163]
  s_lshl_b32 s50, s7, 18
  s_add_u32 s49, s49, s3
  s_lshl_b32 s49, s49, 7
  v_mfma_f32_16x16x32_bf16 v[164:167], v[36:39], v[88:91], v[164:167]
  s_add_u32 s49, s49, 25165824
  s_lshl_b32 s7, s40, 13
  s_add_u32 s7, s7, s50
  v_mfma_f32_16x16x32_bf16 v[176:179], v[32:35], v[92:95], v[176:179]
  s_add_u32 s8, s32, s7
  s_addc_u32 s9, s33, 0
  s_mov_b32 s10, 0x40000
  v_mfma_f32_16x16x32_bf16 v[180:183], v[36:39], v[92:95], v[180:183]
  s_lshl_b32 s47, s6, 15
  s_add_u32 s47, s47, s7
  s_add_u32 s48, s47, 4096
  v_mfma_f32_16x16x32_bf16 v[136:139], v[80:83], v[40:43], v[136:139]
  s_lshl_b32 s46, s3, 13
  v_lshlrev_b32 v3, 4, v0
  v_add_u32 v2, s46, v3
  v_mfma_f32_16x16x32_bf16 v[140:143], v[80:83], v[44:47], v[140:143]
  s_cmp_eq_u32 s4, 0
  s_cselect_b32 s12, s20, s26
  s_cselect_b32 s13, s21, s27
  v_mfma_f32_16x16x32_bf16 v[152:155], v[84:87], v[40:43], v[152:155]
  s_lshl_b32 s7, s6, 8
  s_add_u32 s12, s12, s7
  s_addc_u32 s13, s13, 0
  v_mfma_f32_16x16x32_bf16 v[156:159], v[84:87], v[44:47], v[156:159]
  s_sub_u32 s14, 0x200000, s7
  s_mov_b32 s44, 0
  s_mov_b32 s56, 0xfff8fff8
  v_mfma_f32_16x16x32_bf16 v[168:171], v[40:43], v[88:91], v[168:171]
  s_mov_b32 s57, s56
  s_mov_b32 s58, 0x3e8293ee
  s_mov_b32 s59, s58
  v_mfma_f32_16x16x32_bf16 v[172:175], v[44:47], v[88:91], v[172:175]
  v_mfma_f32_16x16x32_bf16 v[184:187], v[40:43], v[92:95], v[184:187]
  v_mfma_f32_16x16x32_bf16 v[188:191], v[44:47], v[92:95], v[188:191]
  v_mfma_f32_16x16x32_bf16 v[96:99], v[72:75], v[32:35], v[96:99]
  v_cvt_pk_bf16_f32 v48, v128, v129
  v_cvt_pk_bf16_f32 v49, v130, v131
  v_cvt_pk_bf16_f32 v50, v132, v133
  v_cvt_pk_bf16_f32 v51, v134, v135
  v_mfma_f32_16x16x32_bf16 v[100:103], v[72:75], v[36:39], v[100:103]
  v_mfma_f32_16x16x32_bf16 v[104:107], v[72:75], v[40:43], v[104:107]
  v_cvt_pk_bf16_f32 v52, v144, v145
  v_cvt_pk_bf16_f32 v53, v146, v147
  v_cvt_pk_bf16_f32 v54, v148, v149
  v_cvt_pk_bf16_f32 v55, v150, v151
  v_permlane16_swap_b32 v48, v50
  v_permlane16_swap_b32 v49, v51
  buffer_store_dwordx4 v[48:51], v3, s[36:39], s47 offen offset:0 sc1
  ds_write_b128 v2, v[48:51] offset:0
  v_mfma_f32_16x16x32_bf16 v[108:111], v[72:75], v[44:47], v[108:111]
  v_mfma_f32_16x16x32_bf16 v[112:115], v[76:79], v[32:35], v[112:115]
  v_cvt_pk_bf16_f32 v56, v160, v161
  v_cvt_pk_bf16_f32 v57, v162, v163
  v_cvt_pk_bf16_f32 v58, v176, v177
  v_cvt_pk_bf16_f32 v59, v178, v179
  v_permlane16_swap_b32 v52, v54
  v_permlane16_swap_b32 v53, v55
  buffer_store_dwordx4 v[52:55], v3, s[36:39], s47 offen offset:1024 sc1
  ds_write_b128 v2, v[52:55] offset:1024
  v_mfma_f32_16x16x32_bf16 v[116:119], v[76:79], v[36:39], v[116:119]
  v_mfma_f32_16x16x32_bf16 v[120:123], v[76:79], v[40:43], v[120:123]
  v_cvt_pk_bf16_f32 v60, v164, v165
  v_cvt_pk_bf16_f32 v61, v166, v167
  v_cvt_pk_bf16_f32 v62, v180, v181
  v_cvt_pk_bf16_f32 v63, v182, v183
  v_permlane16_swap_b32 v56, v58
  v_permlane16_swap_b32 v57, v59
  buffer_store_dwordx4 v[56:59], v3, s[36:39], s47 offen offset:2048 sc1
  ds_write_b128 v2, v[56:59] offset:2048
  v_mfma_f32_16x16x32_bf16 v[124:127], v[76:79], v[44:47], v[124:127]
  v_cvt_pk_bf16_f32 v32, v136, v137
  v_cvt_pk_bf16_f32 v33, v138, v139
  v_cvt_pk_bf16_f32 v34, v140, v141
  v_cvt_pk_bf16_f32 v35, v142, v143
  v_permlane16_swap_b32 v60, v62
  v_permlane16_swap_b32 v61, v63
  buffer_store_dwordx4 v[60:63], v3, s[36:39], s47 offen offset:3072 sc1
  ds_write_b128 v2, v[60:63] offset:3072
  v_cvt_pk_bf16_f32 v36, v152, v153
  v_cvt_pk_bf16_f32 v37, v154, v155
  v_cvt_pk_bf16_f32 v38, v156, v157
  v_cvt_pk_bf16_f32 v39, v158, v159
  v_permlane16_swap_b32 v32, v34
  v_permlane16_swap_b32 v33, v35
  ds_write_b128 v2, v[32:35] offset:4096
  v_cvt_pk_bf16_f32 v40, v168, v169
  v_cvt_pk_bf16_f32 v41, v170, v171
  v_cvt_pk_bf16_f32 v42, v184, v185
  v_cvt_pk_bf16_f32 v43, v186, v187
  v_permlane16_swap_b32 v36, v38
  v_permlane16_swap_b32 v37, v39
  ds_write_b128 v2, v[36:39] offset:5120
  v_cvt_pk_bf16_f32 v44, v172, v173
  v_cvt_pk_bf16_f32 v45, v174, v175
  v_cvt_pk_bf16_f32 v46, v188, v189
  v_cvt_pk_bf16_f32 v47, v190, v191
  v_permlane16_swap_b32 v40, v42
  v_permlane16_swap_b32 v41, v43
  ds_write_b128 v2, v[40:43] offset:6144
  v_pk_mul_f32 v[96:97], v[96:97], s[58:59]
  v_pk_mul_f32 v[98:99], v[98:99], s[58:59]
  v_pk_mul_f32 v[100:101], v[100:101], s[58:59]
  v_pk_mul_f32 v[102:103], v[102:103], s[58:59]
  v_permlane16_swap_b32 v44, v46
  v_permlane16_swap_b32 v45, v47
  ds_write_b128 v2, v[44:47] offset:7168
  v_pk_mul_f32 v[104:105], v[104:105], s[58:59]
  v_pk_mul_f32 v[106:107], v[106:107], s[58:59]
  v_pk_mul_f32 v[108:109], v[108:109], s[58:59]
  v_pk_mul_f32 v[110:111], v[110:111], s[58:59]
  v_pk_mul_f32 v[112:113], v[112:113], s[58:59]
  v_pk_mul_f32 v[114:115], v[114:115], s[58:59]
  v_pk_mul_f32 v[116:117], v[116:117], s[58:59]
  v_pk_mul_f32 v[118:119], v[118:119], s[58:59]
  v_pk_mul_f32 v[120:121], v[120:121], s[58:59]
  v_pk_mul_f32 v[122:123], v[122:123], s[58:59]
  v_pk_mul_f32 v[124:125], v[124:125], s[58:59]
  v_pk_mul_f32 v[126:127], v[126:127], s[58:59]
  v_cvt_pk_bf16_f32 v16, v96, v97
  v_cvt_pk_bf16_f32 v17, v98, v99
  v_cvt_pk_bf16_f32 v18, v100, v101
  v_cvt_pk_bf16_f32 v19, v102, v103
  v_cvt_pk_bf16_f32 v20, v112, v113
  v_cvt_pk_bf16_f32 v21, v114, v115
  v_cvt_pk_bf16_f32 v22, v116, v117
  v_cvt_pk_bf16_f32 v23, v118, v119
  v_cvt_pk_bf16_f32 v24, v104, v105
  v_cvt_pk_bf16_f32 v25, v106, v107
  v_cvt_pk_bf16_f32 v26, v108, v109
  v_cvt_pk_bf16_f32 v27, v110, v111
  v_cvt_pk_bf16_f32 v28, v120, v121
  v_cvt_pk_bf16_f32 v29, v122, v123
  v_cvt_pk_bf16_f32 v30, v124, v125
  v_cvt_pk_bf16_f32 v31, v126, v127
  s_lshl_b32 s7, s41, 15
  v_add_u32 v2, s7, v3
  s_add_u32 s46, s46, 65536
  s_add_u32 s7, s40, 1
  s_and_b32 s7, s7, 3
  s_lshl_b32 s7, s7, 13
  v_add_u32 v6, s7, v2
  s_add_u32 s7, s40, 2
  s_and_b32 s7, s7, 3
  s_lshl_b32 s7, s7, 13
  v_add_u32 v7, s7, v2
  s_add_u32 s7, s40, 3
  s_and_b32 s7, s7, 3
  s_lshl_b32 s7, s7, 13
  v_add_u32 v8, s7, v2
  v_permlane16_swap_b32 v16, v18
  v_permlane16_swap_b32 v17, v19
  v_permlane16_swap_b32 v20, v22
  v_permlane16_swap_b32 v21, v23
  v_permlane16_swap_b32 v24, v26
  v_permlane16_swap_b32 v25, v27
  v_permlane16_swap_b32 v28, v30
  v_permlane16_swap_b32 v29, v31
  s_nop 0
  v_mfma_f32_32x32x16_bf16 v[128:143], v[48:51], v[16:19], 0
  v_mfma_f32_32x32x16_bf16 v[128:143], v[52:55], v[20:23], v[128:143]
  v_mfma_f32_32x32x16_bf16 v[144:159], v[48:51], v[24:27], 0
  v_mfma_f32_32x32x16_bf16 v[144:159], v[52:55], v[28:31], v[144:159]
  s_waitcnt vmcnt(4)
  s_mov_b32 s7, 65536
L_nonce:
  v_readfirstlane_b32 s34, v238
  v_readfirstlane_b32 s35, v239
  s_sub_u32 s7, s7, 1
  s_cbranch_scc1 L_nonce_done
  s_cmp_eq_u32 s34, 0
  s_cbranch_scc1 L_nonce_retry
L_nonce_done:
  s_nop 3
  v_max3_f32 v4, v128, v129, v130
  v_max3_f32 v4, v4, v131, v132
  v_max3_f32 v4, v4, v133, v134
  v_max3_f32 v4, v4, v135, v136
  v_max3_f32 v4, v4, v137, v138
  v_max3_f32 v4, v4, v139, v140
  v_max3_f32 v4, v4, v141, v142
  v_max_f32 v4, v4, v143
  v_mov_b32 v5, v4
  s_nop 1
  v_permlane32_swap_b32 v4, v5
  s_nop 1
  v_max_f32 v4, v4, v5
  v_sub_f32 v4, 0, v4
  v_mov_b32 v5, v4
  v_mov_b64 v[96:97], v[4:5]
  v_mov_b64 v[98:99], v[4:5]
  v_mov_b64 v[100:101], v[4:5]
  v_mov_b64 v[102:103], v[4:5]
  v_mov_b64 v[104:105], v[4:5]
  v_mov_b64 v[106:107], v[4:5]
  v_mov_b64 v[108:109], v[4:5]
  v_mov_b64 v[110:111], v[4:5]
  s_nop 1
  v_mfma_f32_32x32x16_bf16 v[128:143], v[48:51], v[16:19], v[96:111]
  v_mfma_f32_32x32x16_bf16 v[128:143], v[52:55], v[20:23], v[128:143]
  v_max3_f32 v10, v144, v145, v146
  v_max3_f32 v10, v10, v147, v148
  v_max3_f32 v10, v10, v149, v150
  v_max3_f32 v10, v10, v151, v152
  v_max3_f32 v10, v10, v153, v154
  v_max3_f32 v10, v10, v155, v156
  v_max3_f32 v10, v10, v157, v158
  v_max_f32 v10, v10, v159
  v_mov_b32 v11, v10
  s_nop 1
  v_permlane32_swap_b32 v10, v11
  s_nop 1
  v_max_f32 v10, v10, v11
  v_sub_f32 v10, 0, v10
  v_mov_b32 v11, v10
  v_mov_b64 v[112:113], v[10:11]
  v_mov_b64 v[114:115], v[10:11]
  v_mov_b64 v[116:117], v[10:11]
  v_mov_b64 v[118:119], v[10:11]
  v_mov_b64 v[120:121], v[10:11]
  v_mov_b64 v[122:123], v[10:11]
  v_mov_b64 v[124:125], v[10:11]
  v_mov_b64 v[126:127], v[10:11]
  s_nop 1
  s_cmp_eq_u32 s41, 1
  s_cbranch_scc0 L_noprio
  s_setprio 1
L_noprio:
  s_nop 0
  v_mfma_f32_32x32x16_bf16 v[144:159], v[48:51], v[24:27], v[112:127]
  v_exp_f32 v128, v128
  v_exp_f32 v129, v129
  v_exp_f32 v130, v130
  s_nop 0
  v_mfma_f32_32x32x16_bf16 v[144:159], v[52:55], v[28:31], v[144:159]
  v_exp_f32 v131, v131
  v_exp_f32 v132, v132
  v_exp_f32 v133, v133
  v_exp_f32 v134, v134
  v_exp_f32 v135, v135
  v_exp_f32 v136, v136
  v_exp_f32 v137, v137
  v_exp_f32 v138, v138
  s_nop 0
  v_smfmac_f32_32x32x32_bf16 v[192:207], v[56:59], v[128:135], v236
  v_exp_f32 v139, v139
  v_exp_f32 v140, v140
  v_exp_f32 v141, v141
  s_nop 0
  v_smfmac_f32_16x16x64_bf16 v[224:227], v[232:235], v[128:135], v236
  v_exp_f32 v142, v142
  v_exp_f32 v143, v143
  s_nop 0
  v_mfma_f32_32x32x16_bf16 v[160:175], v[32:35], v[16:19], v[96:111]
  v_exp_f32 v144, v144
  v_exp_f32 v145, v145
  v_exp_f32 v146, v146
  s_nop 0
  v_mfma_f32_32x32x16_bf16 v[160:175], v[36:39], v[20:23], v[160:175]
  v_exp_f32 v147, v147
  v_exp_f32 v148, v148
  v_exp_f32 v149, v149
  s_nop 0
  v_smfmac_f32_32x32x32_bf16 v[192:207], v[60:63], v[136:143], v236
  v_exp_f32 v150, v150
  v_exp_f32 v151, v151
  v_exp_f32 v152, v152
  s_nop 0
  v_smfmac_f32_16x16x64_bf16 v[224:227], v[232:235], v[136:143], v236
  v_exp_f32 v153, v153
  v_exp_f32 v154, v154
  s_nop 0
  v_smfmac_f32_32x32x32_bf16 v[208:223], v[56:59], v[144:151], v236
  v_exp_f32 v155, v155
  v_exp_f32 v156, v156
  v_exp_f32 v157, v157
  s_nop 0
  v_smfmac_f32_16x16x64_bf16 v[228:231], v[232:235], v[144:151], v236
  v_exp_f32 v158, v158
  v_exp_f32 v159, v159
  s_waitcnt lgkmcnt(0)
  s_barrier
  s_nop 0
  v_mfma_f32_32x32x16_bf16 v[176:191], v[32:35], v[24:27], v[112:127]
  v_exp_f32 v160, v160
  v_exp_f32 v161, v161
  v_exp_f32 v162, v162
  ds_read_b128 v[64:67], v6 offset:0
  ds_read_b128 v[68:71], v6 offset:1024
  v_mfma_f32_32x32x16_bf16 v[176:191], v[36:39], v[28:31], v[176:191]
  v_exp_f32 v163, v163
  v_exp_f32 v164, v164
  v_exp_f32 v165, v165
  s_nop 0
  v_smfmac_f32_32x32x32_bf16 v[208:223], v[60:63], v[152:159], v236
  v_exp_f32 v166, v166
  v_exp_f32 v167, v167
  v_exp_f32 v168, v168
  s_nop 0
  v_smfmac_f32_16x16x64_bf16 v[228:231], v[232:235], v[152:159], v236
  v_exp_f32 v169, v169
  v_exp_f32 v170, v170
  ds_read_b128 v[80:83], v6 offset:2048
  ds_read_b128 v[84:87], v6 offset:3072
  v_smfmac_f32_32x32x32_bf16 v[192:207], v[40:43], v[160:167], v236
  v_exp_f32 v171, v171
  v_exp_f32 v172, v172
  v_exp_f32 v173, v173
  s_nop 0
  v_smfmac_f32_16x16x64_bf16 v[224:227], v[232:235], v[160:167], v236
  v_exp_f32 v174, v174
  v_exp_f32 v175, v175
  s_waitcnt lgkmcnt(2)
  v_mfma_f32_32x32x16_bf16 v[128:143], v[64:67], v[16:19], v[96:111]
  v_exp_f32 v176, v176
  v_exp_f32 v177, v177
  v_exp_f32 v178, v178
  s_nop 0
  v_mfma_f32_32x32x16_bf16 v[128:143], v[68:71], v[20:23], v[128:143]
  v_exp_f32 v179, v179
  v_exp_f32 v180, v180
  v_exp_f32 v181, v181
  s_nop 0
  v_smfmac_f32_32x32x32_bf16 v[192:207], v[44:47], v[168:175], v236
  v_exp_f32 v182, v182
  v_exp_f32 v183, v183
  v_exp_f32 v184, v184
  s_nop 0
  v_smfmac_f32_16x16x64_bf16 v[224:227], v[232:235], v[168:175], v236
  v_exp_f32 v185, v185
  v_exp_f32 v186, v186
  s_nop 0
  v_smfmac_f32_32x32x32_bf16 v[208:223], v[40:43], v[176:183], v236
  v_exp_f32 v187, v187
  v_exp_f32 v188, v188
  v_exp_f32 v189, v189
  s_nop 0
  v_smfmac_f32_16x16x64_bf16 v[228:231], v[232:235], v[176:183], v236
  v_exp_f32 v190, v190
  v_exp_f32 v191, v191
  s_waitcnt vmcnt(0)
  s_mov_b64 exec, 1
  buffer_store_dwordx2 v[238:239], v241, s[36:39], s49 offen offset:0 sc1
  s_mov_b64 exec, -1
  s_waitcnt lgkmcnt(0)
  v_mfma_f32_32x32x16_bf16 v[144:159], v[64:67], v[24:27], v[112:127]
  v_exp_f32 v128, v128
  v_exp_f32 v129, v129
  v_exp_f32 v130, v130
  ds_read_b128 v[72:75], v6 offset:4096
  ds_read_b128 v[76:79], v6 offset:5120
  v_mfma_f32_32x32x16_bf16 v[144:159], v[68:71], v[28:31], v[144:159]
  v_exp_f32 v131, v131
  v_exp_f32 v132, v132
  v_exp_f32 v133, v133
  s_nop 0
  v_smfmac_f32_32x32x32_bf16 v[208:223], v[44:47], v[184:191], v236
  v_exp_f32 v134, v134
  v_exp_f32 v135, v135
  v_exp_f32 v136, v136
  s_nop 0
  v_smfmac_f32_16x16x64_bf16 v[228:231], v[232:235], v[184:191], v236
  v_exp_f32 v137, v137
  v_exp_f32 v138, v138
  ds_read_b128 v[88:91], v6 offset:6144
  ds_read_b128 v[92:95], v6 offset:7168
  v_smfmac_f32_32x32x32_bf16 v[192:207], v[80:83], v[128:135], v236
  v_exp_f32 v139, v139
  v_exp_f32 v140, v140
  v_exp_f32 v141, v141
  s_nop 0
  v_smfmac_f32_16x16x64_bf16 v[224:227], v[232:235], v[128:135], v236
  v_exp_f32 v142, v142
  v_exp_f32 v143, v143
  s_waitcnt lgkmcnt(2)
  v_mfma_f32_32x32x16_bf16 v[160:175], v[72:75], v[16:19], v[96:111]
  v_exp_f32 v144, v144
  v_exp_f32 v145, v145
  v_exp_f32 v146, v146
  s_nop 0
  v_mfma_f32_32x32x16_bf16 v[160:175], v[76:79], v[20:23], v[160:175]
  v_exp_f32 v147, v147
  v_exp_f32 v148, v148
  v_exp_f32 v149, v149
  s_nop 0
  v_smfmac_f32_32x32x32_bf16 v[192:207], v[84:87], v[136:143], v236
  v_exp_f32 v150, v150
  v_exp_f32 v151, v151
  v_exp_f32 v152, v152
  s_nop 0
  v_smfmac_f32_16x16x64_bf16 v[224:227], v[232:235], v[136:143], v236
  v_exp_f32 v153, v153
  v_exp_f32 v154, v154
  s_nop 0
  v_smfmac_f32_32x32x32_bf16 v[208:223], v[80:83], v[144:151], v236
  v_exp_f32 v155, v155
  v_exp_f32 v156, v156
  v_exp_f32 v157, v157
  s_nop 0
  v_smfmac_f32_16x16x64_bf16 v[228:231], v[232:235], v[144:151], v236
  v_exp_f32 v158, v158
  v_exp_f32 v159, v159
  s_waitcnt lgkmcnt(0)
  v_mfma_f32_32x32x16_bf16 v[176:191], v[72:75], v[24:27], v[112:127]
  v_exp_f32 v160, v160
  v_exp_f32 v161, v161
  v_exp_f32 v162, v162
  ds_read_b128 v[64:67], v7 offset:0
  ds_read_b128 v[68:71], v7 offset:1024
  v_mfma_f32_32x32x16_bf16 v[176:191], v[76:79], v[28:31], v[176:191]
  v_exp_f32 v163, v163
  v_exp_f32 v164, v164
  v_exp_f32 v165, v165
  s_nop 0
  v_smfmac_f32_32x32x32_bf16 v[208:223], v[84:87], v[152:159], v236
  v_exp_f32 v166, v166
  v_exp_f32 v167, v167
  v_exp_f32 v168, v168
  s_nop 0
  v_smfmac_f32_16x16x64_bf16 v[228:231], v[232:235], v[152:159], v236
  v_exp_f32 v169, v169
  v_exp_f32 v170, v170
  ds_read_b128 v[80:83], v7 offset:2048
  ds_read_b128 v[84:87], v7 offset:3072
  v_smfmac_f32_32x32x32_bf16 v[192:207], v[88:91], v[160:167], v236
  v_exp_f32 v171, v171
  v_exp_f32 v172, v172
  v_exp_f32 v173, v173
  s_nop 0
  v_smfmac_f32_16x16x64_bf16 v[224:227], v[232:235], v[160:167], v236
  v_exp_f32 v174, v174
  v_exp_f32 v175, v175
  s_waitcnt lgkmcnt(2)
  v_mfma_f32_32x32x16_bf16 v[128:143], v[64:67], v[16:19], v[96:111]
  v_exp_f32 v176, v176
  v_exp_f32 v177, v177
  v_exp_f32 v178, v178
  s_nop 0
  v_mfma_f32_32x32x16_bf16 v[128:143], v[68:71], v[20:23], v[128:143]
  v_exp_f32 v179, v179
  v_exp_f32 v180, v180
  v_exp_f32 v181, v181
  s_nop 0
  v_smfmac_f32_32x32x32_bf16 v[192:207], v[92:95], v[168:175], v236
  v_exp_f32 v182, v182
  v_exp_f32 v183, v183
  v_exp_f32 v184, v184
  s_nop 0
  v_smfmac_f32_16x16x64_bf16 v[224:227], v[232:235], v[168:175], v236
  v_exp_f32 v185, v185
  v_exp_f32 v186, v186
  s_nop 0
  v_smfmac_f32_32x32x32_bf16 v[208:223], v[88:91], v[176:183], v236
  v_exp_f32 v187, v187
  v_exp_f32 v188, v188
  v_exp_f32 v189, v189
  s_nop 0
  v_smfmac_f32_16x16x64_bf16 v[228:231], v[232:235], v[176:183], v236
  v_exp_f32 v190, v190
  v_exp_f32 v191, v191
  s_mov_b32 s7, 65536
  buffer_load_dwordx2 v[242:243], v240, s[36:39], s49 offen sc1
L_poll0:
  s_waitcnt vmcnt(0)
  v_cmp_eq_u64 vcc, s[34:35], v[242:243]
  s_or_b64 vcc, vcc, s[56:57]
  s_cmp_eq_u64 vcc, exec
  s_cbranch_scc1 L_poll0_done
  s_sub_u32 s7, s7, 1
  s_cbranch_scc1 L_poll0_done
  s_sleep 8
  buffer_load_dwordx2 v[242:243], v240, s[36:39], s49 offen sc1
  s_branch L_poll0
L_poll0_done:
  s_mov_b32 s42, 0
  s_mov_b32 s56, 0xff00ff00
  s_mov_b32 s57, s56
  s_lshl_b32 s43, s42, 1
  s_cmp_ge_u32 s43, 7
  s_cselect_b32 s7, 7, 0
  s_cselect_b32 s51, 4096, 0
  s_sub_u32 s43, s43, s7
  s_cmp_ge_u32 s43, s6
  s_addc_u32 s43, s43, 0
  s_lshl_b32 s43, s43, 15
  s_add_u32 s43, s43, s51
  s_lshl_b32 s45, s42, 1
  s_add_u32 s45, s45, 1
  s_cmp_ge_u32 s45, 7
  s_cselect_b32 s7, 7, 0
  s_cselect_b32 s51, 4096, 0
  s_sub_u32 s45, s45, s7
  s_cmp_ge_u32 s45, s6
  s_addc_u32 s45, s45, 0
  s_lshl_b32 s45, s45, 15
  s_add_u32 s45, s45, s51
  s_waitcnt lgkmcnt(0)
  v_mfma_f32_32x32x16_bf16 v[144:159], v[64:67], v[24:27], v[112:127]
  v_exp_f32 v128, v128
  v_exp_f32 v129, v129
  v_exp_f32 v130, v130
  ds_read_b128 v[72:75], v7 offset:4096
  ds_read_b128 v[76:79], v7 offset:5120
  v_mfma_f32_32x32x16_bf16 v[144:159], v[68:71], v[28:31], v[144:159]
  v_exp_f32 v131, v131
  v_exp_f32 v132, v132
  v_exp_f32 v133, v133
  s_mov_b32 m0, s46
  s_nop 0
  buffer_load_dwordx4 v246, s[8:11], s43 offen offset:0 sc1 lds
  s_add_u32 s43, s43, s44
  v_smfmac_f32_32x32x32_bf16 v[208:223], v[92:95], v[184:191], v236
  v_exp_f32 v134, v134
  v_exp_f32 v135, v135
  v_exp_f32 v136, v136
  buffer_load_dwordx4 v247, s[8:11], s43 offen offset:1024 sc1 lds
  s_add_u32 s43, s43, s44
  v_smfmac_f32_16x16x64_bf16 v[228:231], v[232:235], v[184:191], v236
  v_exp_f32 v137, v137
  v_exp_f32 v138, v138
  ds_read_b128 v[88:91], v7 offset:6144
  ds_read_b128 v[92:95], v7 offset:7168
  v_smfmac_f32_32x32x32_bf16 v[192:207], v[80:83], v[128:135], v236
  v_exp_f32 v139, v139
  v_exp_f32 v140, v140
  v_exp_f32 v141, v141
  buffer_load_dwordx4 v246, s[8:11], s43 offen offset:2048 sc1 lds
  s_add_u32 s43, s43, s44
  v_smfmac_f32_16x16x64_bf16 v[224:227], v[232:235], v[128:135], v236
  v_exp_f32 v142, v142
  v_exp_f32 v143, v143
  s_waitcnt lgkmcnt(2)
  v_mfma_f32_32x32x16_bf16 v[160:175], v[72:75], v[16:19], v[96:111]
  v_exp_f32 v144, v144
  v_exp_f32 v145, v145
  v_exp_f32 v146, v146
  s_nop 0
  v_mfma_f32_32x32x16_bf16 v[160:175], v[76:79], v[20:23], v[160:175]
  v_exp_f32 v147, v147
  v_exp_f32 v148, v148
  v_exp_f32 v149, v149
  buffer_load_dwordx4 v247, s[8:11], s43 offen offset:3072 sc1 lds
  s_add_u32 m0, s46, 4096
  s_mov_b32 s43, s45
  v_smfmac_f32_32x32x32_bf16 v[192:207], v[84:87], v[136:143], v236
  v_exp_f32 v150, v150
  v_exp_f32 v151, v151
  v_exp_f32 v152, v152
  buffer_load_dwordx4 v246, s[8:11], s43 offen offset:0 sc1 lds
  s_add_u32 s43, s43, s44
  v_smfmac_f32_16x16x64_bf16 v[224:227], v[232:235], v[136:143], v236
  v_exp_f32 v153, v153
  v_exp_f32 v154, v154
  s_nop 0
  v_smfmac_f32_32x32x32_bf16 v[208:223], v[80:83], v[144:151], v236
  v_exp_f32 v155, v155
  v_exp_f32 v156, v156
  v_exp_f32 v157, v157
  buffer_load_dwordx4 v247, s[8:11], s43 offen offset:1024 sc1 lds
  s_add_u32 s43, s43, s44
  v_smfmac_f32_16x16x64_bf16 v[228:231], v[232:235], v[144:151], v236
  v_exp_f32 v158, v158
  v_exp_f32 v159, v159
  s_waitcnt lgkmcnt(0)
  v_mfma_f32_32x32x16_bf16 v[176:191], v[72:75], v[24:27], v[112:127]
  v_exp_f32 v160, v160
  v_exp_f32 v161, v161
  v_exp_f32 v162, v162
  ds_read_b128 v[64:67], v8 offset:0
  ds_read_b128 v[68:71], v8 offset:1024
  v_mfma_f32_32x32x16_bf16 v[176:191], v[76:79], v[28:31], v[176:191]
  v_exp_f32 v163, v163
  v_exp_f32 v164, v164
  v_exp_f32 v165, v165
  buffer_load_dwordx4 v246, s[8:11], s43 offen offset:2048 sc1 lds
  s_add_u32 s43, s43, s44
  v_smfmac_f32_32x32x32_bf16 v[208:223], v[84:87], v[152:159], v236
  v_exp_f32 v166, v166
  v_exp_f32 v167, v167
  v_exp_f32 v168, v168
  buffer_load_dwordx4 v247, s[8:11], s43 offen offset:3072 sc1 lds
  s_xor_b32 s46, s46, 65536
  v_smfmac_f32_16x16x64_bf16 v[228:231], v[232:235], v[152:159], v236
  v_exp_f32 v169, v169
  v_exp_f32 v170, v170
  ds_read_b128 v[80:83], v8 offset:2048
  ds_read_b128 v[84:87], v8 offset:3072
  v_smfmac_f32_32x32x32_bf16 v[192:207], v[88:91], v[160:167], v236
  v_exp_f32 v171, v171
  v_exp_f32 v172, v172
  v_exp_f32 v173, v173
  s_nop 0
  v_smfmac_f32_16x16x64_bf16 v[224:227], v[232:235], v[160:167], v236
  v_exp_f32 v174, v174
  v_exp_f32 v175, v175
  s_waitcnt lgkmcnt(2)
  v_mfma_f32_32x32x16_bf16 v[128:143], v[64:67], v[16:19], v[96:111]
  v_exp_f32 v176, v176
  v_exp_f32 v177, v177
  v_exp_f32 v178, v178
  s_nop 0
  v_mfma_f32_32x32x16_bf16 v[128:143], v[68:71], v[20:23], v[128:143]
  v_exp_f32 v179, v179
  v_exp_f32 v180, v180
  v_exp_f32 v181, v181
  s_nop 0
  v_smfmac_f32_32x32x32_bf16 v[192:207], v[92:95], v[168:175], v236
  v_exp_f32 v182, v182
  v_exp_f32 v183, v183
  v_exp_f32 v184, v184
  buffer_store_dwordx4 v[32:35], v3, s[36:39], s48 offen offset:0 sc1
  v_smfmac_f32_16x16x64_bf16 v[224:227], v[232:235], v[168:175], v236
  v_exp_f32 v185, v185
  v_exp_f32 v186, v186
  s_nop 0
  v_smfmac_f32_32x32x32_bf16 v[208:223], v[88:91], v[176:183], v236
  v_exp_f32 v187, v187
  v_exp_f32 v188, v188
  v_exp_f32 v189, v189
  s_nop 0
  v_smfmac_f32_16x16x64_bf16 v[228:231], v[232:235], v[176:183], v236
  v_exp_f32 v190, v190
  v_exp_f32 v191, v191
  s_waitcnt lgkmcnt(0)
  v_mfma_f32_32x32x16_bf16 v[144:159], v[64:67], v[24:27], v[112:127]
  v_exp_f32 v128, v128
  v_exp_f32 v129, v129
  v_exp_f32 v130, v130
  ds_read_b128 v[72:75], v8 offset:4096
  ds_read_b128 v[76:79], v8 offset:5120
  v_mfma_f32_32x32x16_bf16 v[144:159], v[68:71], v[28:31], v[144:159]
  v_exp_f32 v131, v131
  v_exp_f32 v132, v132
  v_exp_f32 v133, v133
  s_nop 0
  v_smfmac_f32_32x32x32_bf16 v[208:223], v[92:95], v[184:191], v236
  v_exp_f32 v134, v134
  v_exp_f32 v135, v135
  v_exp_f32 v136, v136
  buffer_store_dwordx4 v[36:39], v3, s[36:39], s48 offen offset:1024 sc1
  v_smfmac_f32_16x16x64_bf16 v[228:231], v[232:235], v[184:191], v236
  v_exp_f32 v137, v137
  v_exp_f32 v138, v138
  ds_read_b128 v[88:91], v8 offset:6144
  ds_read_b128 v[92:95], v8 offset:7168
  v_smfmac_f32_32x32x32_bf16 v[192:207], v[80:83], v[128:135], v236
  v_exp_f32 v139, v139
  v_exp_f32 v140, v140
  v_exp_f32 v141, v141
  s_nop 0
  v_smfmac_f32_16x16x64_bf16 v[224:227], v[232:235], v[128:135], v236
  v_exp_f32 v142, v142
  v_exp_f32 v143, v143
  s_waitcnt lgkmcnt(2)
  v_mfma_f32_32x32x16_bf16 v[160:175], v[72:75], v[16:19], v[96:111]
  v_exp_f32 v144, v144
  v_exp_f32 v145, v145
  v_exp_f32 v146, v146
  s_nop 0
  v_mfma_f32_32x32x16_bf16 v[160:175], v[76:79], v[20:23], v[160:175]
  v_exp_f32 v147, v147
  v_exp_f32 v148, v148
  v_exp_f32 v149, v149
  s_nop 0
  v_smfmac_f32_32x32x32_bf16 v[192:207], v[84:87], v[136:143], v236
  v_exp_f32 v150, v150
  v_exp_f32 v151, v151
  v_exp_f32 v152, v152
  buffer_store_dwordx4 v[40:43], v3, s[36:39], s48 offen offset:2048 sc1
  v_smfmac_f32_16x16x64_bf16 v[224:227], v[232:235], v[136:143], v236
  v_exp_f32 v153, v153
  v_exp_f32 v154, v154
  s_nop 0
  v_smfmac_f32_32x32x32_bf16 v[208:223], v[80:83], v[144:151], v236
  v_exp_f32 v155, v155
  v_exp_f32 v156, v156
  v_exp_f32 v157, v157
  s_nop 0
  v_smfmac_f32_16x16x64_bf16 v[228:231], v[232:235], v[144:151], v236
  v_exp_f32 v158, v158
  v_exp_f32 v159, v159
  s_waitcnt vmcnt(3) lgkmcnt(0)
  s_barrier
  v_xor_b32 v2, 0x10000, v2
  s_nop 0
  v_mfma_f32_32x32x16_bf16 v[176:191], v[72:75], v[24:27], v[112:127]
  v_exp_f32 v160, v160
  v_exp_f32 v161, v161
  v_exp_f32 v162, v162
  ds_read_b128 v[64:67], v2 offset:0
  ds_read_b128 v[68:71], v2 offset:1024
  v_mfma_f32_32x32x16_bf16 v[176:191], v[76:79], v[28:31], v[176:191]
  v_exp_f32 v163, v163
  v_exp_f32 v164, v164
  v_exp_f32 v165, v165
  s_nop 0
  v_smfmac_f32_32x32x32_bf16 v[208:223], v[84:87], v[152:159], v236
  v_exp_f32 v166, v166
  v_exp_f32 v167, v167
  v_exp_f32 v168, v168
  s_nop 0
  v_smfmac_f32_16x16x64_bf16 v[228:231], v[232:235], v[152:159], v236
  v_exp_f32 v169, v169
  v_exp_f32 v170, v170
  ds_read_b128 v[80:83], v2 offset:2048
  ds_read_b128 v[84:87], v2 offset:3072
  v_smfmac_f32_32x32x32_bf16 v[192:207], v[88:91], v[160:167], v236
  v_exp_f32 v171, v171
  v_exp_f32 v172, v172
  v_exp_f32 v173, v173
  s_nop 0
  v_smfmac_f32_16x16x64_bf16 v[224:227], v[232:235], v[160:167], v236
  v_exp_f32 v174, v174
  v_exp_f32 v175, v175
  s_waitcnt lgkmcnt(2)
  v_mfma_f32_32x32x16_bf16 v[128:143], v[64:67], v[16:19], v[96:111]
  v_exp_f32 v176, v176
  v_exp_f32 v177, v177
  v_exp_f32 v178, v178
  s_nop 0
  v_mfma_f32_32x32x16_bf16 v[128:143], v[68:71], v[20:23], v[128:143]
  v_exp_f32 v179, v179
  v_exp_f32 v180, v180
  v_exp_f32 v181, v181
  s_nop 0
  v_smfmac_f32_32x32x32_bf16 v[192:207], v[92:95], v[168:175], v236
  v_exp_f32 v182, v182
  v_exp_f32 v183, v183
  v_exp_f32 v184, v184
  buffer_store_dwordx4 v[44:47], v3, s[36:39], s48 offen offset:3072 sc1
  v_smfmac_f32_16x16x64_bf16 v[224:227], v[232:235], v[168:175], v236
  v_exp_f32 v185, v185
  v_exp_f32 v186, v186
  s_nop 0
  v_smfmac_f32_32x32x32_bf16 v[208:223], v[88:91], v[176:183], v236
  v_exp_f32 v187, v187
  v_exp_f32 v188, v188
  v_exp_f32 v189, v189
  s_nop 0
  v_smfmac_f32_16x16x64_bf16 v[228:231], v[232:235], v[176:183], v236
  v_exp_f32 v190, v190
  v_exp_f32 v191, v191
  s_mov_b32 s42, 1
.p2align 6
L_at:
  s_andn2_b32 s7, s42, 2
  s_cmp_eq_u32 s7, 1
  s_cbranch_scc0 L_r_ld_skip
  buffer_load_dwordx2 v[242:243], v240, s[36:39], s49 offen sc1
L_r_ld_skip:
  s_waitcnt lgkmcnt(0)
  v_mfma_f32_32x32x16_bf16 v[144:159], v[64:67], v[24:27], v[112:127]
  v_exp_f32 v128, v128
  v_exp_f32 v129, v129
  v_exp_f32 v130, v130
  ds_read_b128 v[72:75], v2 offset:4096
  ds_read_b128 v[76:79], v2 offset:5120
  v_mfma_f32_32x32x16_bf16 v[144:159], v[68:71], v[28:31], v[144:159]
  v_exp_f32 v131, v131
  v_exp_f32 v132, v132
  v_exp_f32 v133, v133
  s_lshl_b32 s43, s42, 1
  s_cmp_ge_u32 s43, 7
  v_smfmac_f32_32x32x32_bf16 v[208:223], v[92:95], v[184:191], v236
  v_exp_f32 v134, v134
  v_exp_f32 v135, v135
  v_exp_f32 v136, v136
  s_cselect_b32 s7, 7, 0
  s_cselect_b32 s51, 4096, 0
  v_smfmac_f32_16x16x64_bf16 v[228:231], v[232:235], v[184:191], v236
  v_exp_f32 v137, v137
  v_exp_f32 v138, v138
  ds_read_b128 v[88:91], v2 offset:6144
  ds_read_b128 v[92:95], v2 offset:7168
  v_smfmac_f32_32x32x32_bf16 v[192:207], v[80:83], v[128:135], v236
  v_exp_f32 v139, v139
  v_exp_f32 v140, v140
  v_exp_f32 v141, v141
  s_sub_u32 s43, s43, s7
  s_cmp_ge_u32 s43, s6
  v_smfmac_f32_16x16x64_bf16 v[224:227], v[232:235], v[128:135], v236
  v_exp_f32 v142, v142
  v_exp_f32 v143, v143
  s_waitcnt lgkmcnt(2)
  v_mfma_f32_32x32x16_bf16 v[160:175], v[72:75], v[16:19], v[96:111]
  v_exp_f32 v144, v144
  v_exp_f32 v145, v145
  v_exp_f32 v146, v146
  s_addc_u32 s43, s43, 0
  s_lshl_b32 s43, s43, 15
  v_mfma_f32_32x32x16_bf16 v[160:175], v[76:79], v[20:23], v[160:175]
  v_exp_f32 v147, v147
  v_exp_f32 v148, v148
  v_exp_f32 v149, v149
  s_add_u32 s43, s43, s51
  s_lshl_b32 s45, s42, 1
  v_smfmac_f32_32x32x32_bf16 v[192:207], v[84:87], v[136:143], v236
  v_exp_f32 v150, v150
  v_exp_f32 v151, v151
  v_exp_f32 v152, v152
  s_add_u32 s45, s45, 1
  s_cmp_ge_u32 s45, 7
  v_smfmac_f32_16x16x64_bf16 v[224:227], v[232:235], v[136:143], v236
  v_exp_f32 v153, v153
  v_exp_f32 v154, v154
  s_cselect_b32 s7, 7, 0
  s_cselect_b32 s51, 4096, 0
  v_smfmac_f32_32x32x32_bf16 v[208:223], v[80:83], v[144:151], v236
  v_exp_f32 v155, v155
  v_exp_f32 v156, v156
  v_exp_f32 v157, v157
  s_sub_u32 s45, s45, s7
  s_cmp_ge_u32 s45, s6
  v_smfmac_f32_16x16x64_bf16 v[228:231], v[232:235], v[144:151], v236
  v_exp_f32 v158, v158
  v_exp_f32 v159, v159
  s_waitcnt lgkmcnt(0)
  v_mfma_f32_32x32x16_bf16 v[176:191], v[72:75], v[24:27], v[112:127]
  v_exp_f32 v160, v160
  v_exp_f32 v161, v161
  v_exp_f32 v162, v162
  ds_read_b128 v[64:67], v2 offset:8192
  ds_read_b128 v[68:71], v2 offset:9216
  v_mfma_f32_32x32x16_bf16 v[176:191], v[76:79], v[28:31], v[176:191]
  v_exp_f32 v163, v163
  v_exp_f32 v164, v164
  v_exp_f32 v165, v165
  s_addc_u32 s45, s45, 0
  s_lshl_b32 s45, s45, 15
  v_smfmac_f32_32x32x32_bf16 v[208:223], v[84:87], v[152:159], v236
  v_exp_f32 v166, v166
  v_exp_f32 v167, v167
  v_exp_f32 v168, v168
  s_add_u32 s45, s45, s51
  v_smfmac_f32_16x16x64_bf16 v[228:231], v[232:235], v[152:159], v236
  v_exp_f32 v169, v169
  v_exp_f32 v170, v170
  ds_read_b128 v[80:83], v2 offset:10240
  ds_read_b128 v[84:87], v2 offset:11264
  v_smfmac_f32_32x32x32_bf16 v[192:207], v[88:91], v[160:167], v236
  v_exp_f32 v171, v171
  v_exp_f32 v172, v172
  v_exp_f32 v173, v173
  s_nop 0
  v_smfmac_f32_16x16x64_bf16 v[224:227], v[232:235], v[160:167], v236
  v_exp_f32 v174, v174
  v_exp_f32 v175, v175
  s_andn2_b32 s7, s42, 2
  s_cmp_eq_u32 s7, 1
  s_cbranch_scc0 L_r_poll_skip
  s_mov_b32 s7, 65536
L_poll2:
  s_waitcnt vmcnt(0)
  v_cmp_eq_u64 vcc, s[34:35], v[242:243]
  s_or_b64 vcc, vcc, s[56:57]
  s_cmp_eq_u64 vcc, exec
  s_cbranch_scc1 L_poll2_done
  s_sub_u32 s7, s7, 1
  s_cbranch_scc1 L_poll2_done
  s_sleep 8
  buffer_load_dwordx2 v[242:243], v240, s[36:39], s49 offen sc1
  s_branch L_poll2
L_poll2_done:
  s_mov_b64 s[56:57], 0
L_r_poll_skip:
  s_waitcnt lgkmcnt(2)
  v_mfma_f32_32x32x16_bf16 v[128:143], v[64:67], v[16:19], v[96:111]
  v_exp_f32 v176, v176
  v_exp_f32 v177, v177
  v_exp_f32 v178, v178
  s_nop 0
  v_mfma_f32_32x32x16_bf16 v[128:143], v[68:71], v[20:23], v[128:143]
  v_exp_f32 v179, v179
  v_exp_f32 v180, v180
  v_exp_f32 v181, v181
  s_mov_b32 m0, s46
  s_nop 0
  buffer_load_dwordx4 v246, s[8:11], s43 offen offset:0 sc1 lds
  s_add_u32 s43, s43, s44
  v_smfmac_f32_32x32x32_bf16 v[192:207], v[92:95], v[168:175], v236
  v_exp_f32 v182, v182
  v_exp_f32 v183, v183
  v_exp_f32 v184, v184
  s_nop 0
  v_smfmac_f32_16x16x64_bf16 v[224:227], v[232:235], v[168:175], v236
  v_exp_f32 v185, v185
  v_exp_f32 v186, v186
  s_nop 0
  v_smfmac_f32_32x32x32_bf16 v[208:223], v[88:91], v[176:183], v236
  v_exp_f32 v187, v187
  v_exp_f32 v188, v188
  v_exp_f32 v189, v189
  buffer_load_dwordx4 v247, s[8:11], s43 offen offset:1024 sc1 lds
  s_add_u32 s43, s43, s44
  v_smfmac_f32_16x16x64_bf16 v[228:231], v[232:235], v[176:183], v236
  v_exp_f32 v190, v190
  v_exp_f32 v191, v191
  s_setprio 0
  s_cmp_eq_u32 s41, 0
  s_cbranch_scc0 L_pa0
  s_setprio 1
L_pa0:
  s_waitcnt lgkmcnt(0)
  v_mfma_f32_32x32x16_bf16 v[144:159], v[64:67], v[24:27], v[112:127]
  v_exp_f32 v128, v128
  v_exp_f32 v129, v129
  v_exp_f32 v130, v130
  ds_read_b128 v[72:75], v2 offset:12288
  ds_read_b128 v[76:79], v2 offset:13312
  v_mfma_f32_32x32x16_bf16 v[144:159], v[68:71], v[28:31], v[144:159]
  v_exp_f32 v131, v131
  v_exp_f32 v132, v132
  v_exp_f32 v133, v133
  buffer_load_dwordx4 v246, s[8:11], s43 offen offset:2048 sc1 lds
  s_add_u32 s43, s43, s44
  v_smfmac_f32_32x32x32_bf16 v[208:223], v[92:95], v[184:191], v236
  v_exp_f32 v134, v134
  v_exp_f32 v135, v135
  v_exp_f32 v136, v136
  s_nop 0
  v_smfmac_f32_16x16x64_bf16 v[228:231], v[232:235], v[184:191], v236
  v_exp_f32 v137, v137
  v_exp_f32 v138, v138
  ds_read_b128 v[88:91], v2 offset:14336
  ds_read_b128 v[92:95], v2 offset:15360
  v_smfmac_f32_32x32x32_bf16 v[192:207], v[80:83], v[128:135], v236
  v_exp_f32 v139, v139
  v_exp_f32 v140, v140
  v_exp_f32 v141, v141
  buffer_load_dwordx4 v247, s[8:11], s43 offen offset:3072 sc1 lds
  s_add_u32 m0, s46, 4096
  s_mov_b32 s43, s45
  v_smfmac_f32_16x16x64_bf16 v[224:227], v[232:235], v[128:135], v236
  v_exp_f32 v142, v142
  v_exp_f32 v143, v143
  s_waitcnt lgkmcnt(2)
  v_mfma_f32_32x32x16_bf16 v[160:175], v[72:75], v[16:19], v[96:111]
  v_exp_f32 v144, v144
  v_exp_f32 v145, v145
  v_exp_f32 v146, v146
  s_nop 0
  v_mfma_f32_32x32x16_bf16 v[160:175], v[76:79], v[20:23], v[160:175]
  v_exp_f32 v147, v147
  v_exp_f32 v148, v148
  v_exp_f32 v149, v149
  buffer_load_dwordx4 v246, s[8:11], s43 offen offset:0 sc1 lds
  s_add_u32 s43, s43, s44
  v_smfmac_f32_32x32x32_bf16 v[192:207], v[84:87], v[136:143], v236
  v_exp_f32 v150, v150
  v_exp_f32 v151, v151
  v_exp_f32 v152, v152
  s_nop 0
  v_smfmac_f32_16x16x64_bf16 v[224:227], v[232:235], v[136:143], v236
  v_exp_f32 v153, v153
  v_exp_f32 v154, v154
  s_nop 0
  v_smfmac_f32_32x32x32_bf16 v[208:223], v[80:83], v[144:151], v236
  v_exp_f32 v155, v155
  v_exp_f32 v156, v156
  v_exp_f32 v157, v157
  buffer_load_dwordx4 v247, s[8:11], s43 offen offset:1024 sc1 lds
  s_add_u32 s43, s43, s44
  v_smfmac_f32_16x16x64_bf16 v[228:231], v[232:235], v[144:151], v236
  v_exp_f32 v158, v158
  v_exp_f32 v159, v159
  s_waitcnt lgkmcnt(0)
  v_mfma_f32_32x32x16_bf16 v[176:191], v[72:75], v[24:27], v[112:127]
  v_exp_f32 v160, v160
  v_exp_f32 v161, v161
  v_exp_f32 v162, v162
  ds_read_b128 v[64:67], v2 offset:16384
  ds_read_b128 v[68:71], v2 offset:17408
  v_mfma_f32_32x32x16_bf16 v[176:191], v[76:79], v[28:31], v[176:191]
  v_exp_f32 v163, v163
  v_exp_f32 v164, v164
  v_exp_f32 v165, v165
  buffer_load_dwordx4 v246, s[8:11], s43 offen offset:2048 sc1 lds
  s_add_u32 s43, s43, s44
  v_smfmac_f32_32x32x32_bf16 v[208:223], v[84:87], v[152:159], v236
  v_exp_f32 v166, v166
  v_exp_f32 v167, v167
  v_exp_f32 v168, v168
  s_nop 0
  v_smfmac_f32_16x16x64_bf16 v[228:231], v[232:235], v[152:159], v236
  v_exp_f32 v169, v169
  v_exp_f32 v170, v170
  ds_read_b128 v[80:83], v2 offset:18432
  ds_read_b128 v[84:87], v2 offset:19456
  v_smfmac_f32_32x32x32_bf16 v[192:207], v[88:91], v[160:167], v236
  v_exp_f32 v171, v171
  v_exp_f32 v172, v172
  v_exp_f32 v173, v173
  buffer_load_dwordx4 v247, s[8:11], s43 offen offset:3072 sc1 lds
  s_xor_b32 s46, s46, 65536
  v_smfmac_f32_16x16x64_bf16 v[224:227], v[232:235], v[160:167], v236
  v_exp_f32 v174, v174
  v_exp_f32 v175, v175
  s_waitcnt lgkmcnt(2)
  v_mfma_f32_32x32x16_bf16 v[128:143], v[64:67], v[16:19], v[96:111]
  v_exp_f32 v176, v176
  v_exp_f32 v177, v177
  v_exp_f32 v178, v178
  s_nop 0
  v_mfma_f32_32x32x16_bf16 v[128:143], v[68:71], v[20:23], v[128:143]
  v_exp_f32 v179, v179
  v_exp_f32 v180, v180
  v_exp_f32 v181, v181
  s_nop 0
  v_smfmac_f32_32x32x32_bf16 v[192:207], v[92:95], v[168:175], v236
  v_exp_f32 v182, v182
  v_exp_f32 v183, v183
  v_exp_f32 v184, v184
  s_nop 0
  v_smfmac_f32_16x16x64_bf16 v[224:227], v[232:235], v[168:175], v236
  v_exp_f32 v185, v185
  v_exp_f32 v186, v186
  s_nop 0
  v_smfmac_f32_32x32x32_bf16 v[208:223], v[88:91], v[176:183], v236
  v_exp_f32 v187, v187
  v_exp_f32 v188, v188
  v_exp_f32 v189, v189
  s_nop 0
  v_smfmac_f32_16x16x64_bf16 v[228:231], v[232:235], v[176:183], v236
  v_exp_f32 v190, v190
  v_exp_f32 v191, v191
  s_waitcnt lgkmcnt(0)
  v_mfma_f32_32x32x16_bf16 v[144:159], v[64:67], v[24:27], v[112:127]
  v_exp_f32 v128, v128
  v_exp_f32 v129, v129
  v_exp_f32 v130, v130
  ds_read_b128 v[72:75], v2 offset:20480
  ds_read_b128 v[76:79], v2 offset:21504
  v_mfma_f32_32x32x16_bf16 v[144:159], v[68:71], v[28:31], v[144:159]
  v_exp_f32 v131, v131
  v_exp_f32 v132, v132
  v_exp_f32 v133, v133
  s_nop 0
  v_smfmac_f32_32x32x32_bf16 v[208:223], v[92:95], v[184:191], v236
  v_exp_f32 v134, v134
  v_exp_f32 v135, v135
  v_exp_f32 v136, v136
  s_nop 0
  v_smfmac_f32_16x16x64_bf16 v[228:231], v[232:235], v[184:191], v236
  v_exp_f32 v137, v137
  v_exp_f32 v138, v138
  ds_read_b128 v[88:91], v2 offset:22528
  ds_read_b128 v[92:95], v2 offset:23552
  v_smfmac_f32_32x32x32_bf16 v[192:207], v[80:83], v[128:135], v236
  v_exp_f32 v139, v139
  v_exp_f32 v140, v140
  v_exp_f32 v141, v141
  s_nop 0
  v_smfmac_f32_16x16x64_bf16 v[224:227], v[232:235], v[128:135], v236
  v_exp_f32 v142, v142
  v_exp_f32 v143, v143
  s_setprio 0
  s_cmp_eq_u32 s41, 1
  s_cbranch_scc0 L_pa1
  s_setprio 1
L_pa1:
  s_waitcnt lgkmcnt(2)
  v_mfma_f32_32x32x16_bf16 v[160:175], v[72:75], v[16:19], v[96:111]
  v_exp_f32 v144, v144
  v_exp_f32 v145, v145
  v_exp_f32 v146, v146
  s_nop 0
  v_mfma_f32_32x32x16_bf16 v[160:175], v[76:79], v[20:23], v[160:175]
  v_exp_f32 v147, v147
  v_exp_f32 v148, v148
  v_exp_f32 v149, v149
  s_nop 0
  v_smfmac_f32_32x32x32_bf16 v[192:207], v[84:87], v[136:143], v236
  v_exp_f32 v150, v150
  v_exp_f32 v151, v151
  v_exp_f32 v152, v152
  s_nop 0
  v_smfmac_f32_16x16x64_bf16 v[224:227], v[232:235], v[136:143], v236
  v_exp_f32 v153, v153
  v_exp_f32 v154, v154
  s_nop 0
  v_smfmac_f32_32x32x32_bf16 v[208:223], v[80:83], v[144:151], v236
  v_exp_f32 v155, v155
  v_exp_f32 v156, v156
  v_exp_f32 v157, v157
  s_nop 0
  v_smfmac_f32_16x16x64_bf16 v[228:231], v[232:235], v[144:151], v236
  v_exp_f32 v158, v158
  v_exp_f32 v159, v159
  s_waitcnt lgkmcnt(0)
  v_mfma_f32_32x32x16_bf16 v[176:191], v[72:75], v[24:27], v[112:127]
  v_exp_f32 v160, v160
  v_exp_f32 v161, v161
  v_exp_f32 v162, v162
  ds_read_b128 v[64:67], v2 offset:24576
  ds_read_b128 v[68:71], v2 offset:25600
  v_mfma_f32_32x32x16_bf16 v[176:191], v[76:79], v[28:31], v[176:191]
  v_exp_f32 v163, v163
  v_exp_f32 v164, v164
  v_exp_f32 v165, v165
  s_nop 0
  v_smfmac_f32_32x32x32_bf16 v[208:223], v[84:87], v[152:159], v236
  v_exp_f32 v166, v166
  v_exp_f32 v167, v167
  v_exp_f32 v168, v168
  s_nop 0
  v_smfmac_f32_16x16x64_bf16 v[228:231], v[232:235], v[152:159], v236
  v_exp_f32 v169, v169
  v_exp_f32 v170, v170
  ds_read_b128 v[80:83], v2 offset:26624
  ds_read_b128 v[84:87], v2 offset:27648
  v_smfmac_f32_32x32x32_bf16 v[192:207], v[88:91], v[160:167], v236
  v_exp_f32 v171, v171
  v_exp_f32 v172, v172
  v_exp_f32 v173, v173
  s_nop 0
  v_smfmac_f32_16x16x64_bf16 v[224:227], v[232:235], v[160:167], v236
  v_exp_f32 v174, v174
  v_exp_f32 v175, v175
  s_waitcnt lgkmcnt(2)
  v_mfma_f32_32x32x16_bf16 v[128:143], v[64:67], v[16:19], v[96:111]
  v_exp_f32 v176, v176
  v_exp_f32 v177, v177
  v_exp_f32 v178, v178
  s_nop 0
  v_mfma_f32_32x32x16_bf16 v[128:143], v[68:71], v[20:23], v[128:143]
  v_exp_f32 v179, v179
  v_exp_f32 v180, v180
  v_exp_f32 v181, v181
  s_nop 0
  v_smfmac_f32_32x32x32_bf16 v[192:207], v[92:95], v[168:175], v236
  v_exp_f32 v182, v182
  v_exp_f32 v183, v183
  v_exp_f32 v184, v184
  s_nop 0
  v_smfmac_f32_16x16x64_bf16 v[224:227], v[232:235], v[168:175], v236
  v_exp_f32 v185, v185
  v_exp_f32 v186, v186
  s_nop 0
  v_smfmac_f32_32x32x32_bf16 v[208:223], v[88:91], v[176:183], v236
  v_exp_f32 v187, v187
  v_exp_f32 v188, v188
  v_exp_f32 v189, v189
  s_nop 0
  v_smfmac_f32_16x16x64_bf16 v[228:231], v[232:235], v[176:183], v236
  v_exp_f32 v190, v190
  v_exp_f32 v191, v191
  s_waitcnt lgkmcnt(0)
  v_mfma_f32_32x32x16_bf16 v[144:159], v[64:67], v[24:27], v[112:127]
  v_exp_f32 v128, v128
  v_exp_f32 v129, v129
  v_exp_f32 v130, v130
  ds_read_b128 v[72:75], v2 offset:28672
  ds_read_b128 v[76:79], v2 offset:29696
  v_mfma_f32_32x32x16_bf16 v[144:159], v[68:71], v[28:31], v[144:159]
  v_exp_f32 v131, v131
  v_exp_f32 v132, v132
  v_exp_f32 v133, v133
  s_nop 0
  v_smfmac_f32_32x32x32_bf16 v[208:223], v[92:95], v[184:191], v236
  v_exp_f32 v134, v134
  v_exp_f32 v135, v135
  v_exp_f32 v136, v136
  s_nop 0
  v_smfmac_f32_16x16x64_bf16 v[228:231], v[232:235], v[184:191], v236
  v_exp_f32 v137, v137
  v_exp_f32 v138, v138
  ds_read_b128 v[88:91], v2 offset:30720
  ds_read_b128 v[92:95], v2 offset:31744
  v_smfmac_f32_32x32x32_bf16 v[192:207], v[80:83], v[128:135], v236
  v_exp_f32 v139, v139
  v_exp_f32 v140, v140
  v_exp_f32 v141, v141
  s_nop 0
  v_smfmac_f32_16x16x64_bf16 v[224:227], v[232:235], v[128:135], v236
  v_exp_f32 v142, v142
  v_exp_f32 v143, v143
  s_waitcnt lgkmcnt(2)
  v_mfma_f32_32x32x16_bf16 v[160:175], v[72:75], v[16:19], v[96:111]
  v_exp_f32 v144, v144
  v_exp_f32 v145, v145
  v_exp_f32 v146, v146
  s_nop 0
  v_mfma_f32_32x32x16_bf16 v[160:175], v[76:79], v[20:23], v[160:175]
  v_exp_f32 v147, v147
  v_exp_f32 v148, v148
  v_exp_f32 v149, v149
  s_nop 0
  v_smfmac_f32_32x32x32_bf16 v[192:207], v[84:87], v[136:143], v236
  v_exp_f32 v150, v150
  v_exp_f32 v151, v151
  v_exp_f32 v152, v152
  s_nop 0
  v_smfmac_f32_16x16x64_bf16 v[224:227], v[232:235], v[136:143], v236
  v_exp_f32 v153, v153
  v_exp_f32 v154, v154
  s_nop 0
  v_smfmac_f32_32x32x32_bf16 v[208:223], v[80:83], v[144:151], v236
  v_exp_f32 v155, v155
  v_exp_f32 v156, v156
  v_exp_f32 v157, v157
  s_nop 0
  v_smfmac_f32_16x16x64_bf16 v[228:231], v[232:235], v[144:151], v236
  v_exp_f32 v158, v158
  v_exp_f32 v159, v159
  s_waitcnt vmcnt(0) lgkmcnt(0)
  s_barrier
  s_cmp_eq_u32 s42, 1
  s_cbranch_scc0 L_r_pub1_skip
  s_mov_b64 exec, 1
  buffer_store_dwordx2 v[238:239], v241, s[36:39], s49 offen offset:64 sc1
  s_mov_b64 exec, -1
L_r_pub1_skip:
  v_xor_b32 v2, 0x10000, v2
  s_nop 0
  v_mfma_f32_32x32x16_bf16 v[176:191], v[72:75], v[24:27], v[112:127]
  v_exp_f32 v160, v160
  v_exp_f32 v161, v161
  v_exp_f32 v162, v162
  ds_read_b128 v[64:67], v2 offset:0
  ds_read_b128 v[68:71], v2 offset:1024
  v_mfma_f32_32x32x16_bf16 v[176:191], v[76:79], v[28:31], v[176:191]
  v_exp_f32 v163, v163
  v_exp_f32 v164, v164
  v_exp_f32 v165, v165
  s_nop 0
  v_smfmac_f32_32x32x32_bf16 v[208:223], v[84:87], v[152:159], v236
  v_exp_f32 v166, v166
  v_exp_f32 v167, v167
  v_exp_f32 v168, v168
  s_nop 0
  v_smfmac_f32_16x16x64_bf16 v[228:231], v[232:235], v[152:159], v236
  v_exp_f32 v169, v169
  v_exp_f32 v170, v170
  ds_read_b128 v[80:83], v2 offset:2048
  ds_read_b128 v[84:87], v2 offset:3072
  v_smfmac_f32_32x32x32_bf16 v[192:207], v[88:91], v[160:167], v236
  v_exp_f32 v171, v171
  v_exp_f32 v172, v172
  v_exp_f32 v173, v173
  s_nop 0
  v_smfmac_f32_16x16x64_bf16 v[224:227], v[232:235], v[160:167], v236
  v_exp_f32 v174, v174
  v_exp_f32 v175, v175
  s_cmp_eq_u32 s42, 4
  s_cbranch_scc0 L_r_pfwo_skip
  s_and_b32 s7, s5, 3
  s_lshl_b32 s7, s7, 3
  s_add_u32 s7, s7, s3
  s_lshl_b32 s7, s7, 16
  v_lshrrev_b32 v4, 1, v0
  v_lshlrev_b32 v4, 11, v4
  v_and_b32 v5, 1, v0
  v_lshl_add_u32 v4, v5, 7, v4
  buffer_load_dword v13, v4, s[12:15], s7 offen
L_r_pfwo_skip:
  s_waitcnt lgkmcnt(2)
  v_mfma_f32_32x32x16_bf16 v[128:143], v[64:67], v[16:19], v[96:111]
  v_exp_f32 v176, v176
  v_exp_f32 v177, v177
  v_exp_f32 v178, v178
  s_nop 0
  v_mfma_f32_32x32x16_bf16 v[128:143], v[68:71], v[20:23], v[128:143]
  v_exp_f32 v179, v179
  v_exp_f32 v180, v180
  v_exp_f32 v181, v181
  s_nop 0
  v_smfmac_f32_32x32x32_bf16 v[192:207], v[92:95], v[168:175], v236
  v_exp_f32 v182, v182
  v_exp_f32 v183, v183
  v_exp_f32 v184, v184
  s_nop 0
  v_smfmac_f32_16x16x64_bf16 v[224:227], v[232:235], v[168:175], v236
  v_exp_f32 v185, v185
  v_exp_f32 v186, v186
  s_nop 0
  v_smfmac_f32_32x32x32_bf16 v[208:223], v[88:91], v[176:183], v236
  v_exp_f32 v187, v187
  v_exp_f32 v188, v188
  v_exp_f32 v189, v189
  s_nop 0
  v_smfmac_f32_16x16x64_bf16 v[228:231], v[232:235], v[176:183], v236
  v_exp_f32 v190, v190
  v_exp_f32 v191, v191
  s_add_u32 s42, s42, 1
  s_cmp_lt_u32 s42, 7
  s_cbranch_scc1 L_at
  s_waitcnt lgkmcnt(0)
  v_mfma_f32_32x32x16_bf16 v[144:159], v[64:67], v[24:27], v[112:127]
  v_exp_f32 v128, v128
  v_exp_f32 v129, v129
  v_exp_f32 v130, v130
  s_mov_b32 s8, s12
  s_mov_b32 s9, s13
  s_mov_b32 s10, s14
  ds_read_b128 v[72:75], v2 offset:4096
  ds_read_b128 v[76:79], v2 offset:5120
  v_mfma_f32_32x32x16_bf16 v[144:159], v[68:71], v[28:31], v[144:159]
  v_exp_f32 v131, v131
  v_exp_f32 v132, v132
  v_exp_f32 v133, v133
  s_lshl_b32 s43, s3, 16
  s_add_u32 s45, s43, 32768
  s_mov_b32 s44, 7168
  s_nop 0
  v_smfmac_f32_32x32x32_bf16 v[208:223], v[92:95], v[184:191], v236
  v_exp_f32 v134, v134
  v_exp_f32 v135, v135
  v_exp_f32 v136, v136
  v_lshrrev_b32 v246, 4, v0
  v_lshlrev_b32 v247, 1, v246
  s_nop 0
  v_smfmac_f32_16x16x64_bf16 v[228:231], v[232:235], v[184:191], v236
  v_exp_f32 v137, v137
  v_exp_f32 v138, v138
  v_and_b32 v4, 15, v0
  v_xor_b32 v247, v247, v4
  s_nop 0
  v_smfmac_f32_32x32x32_bf16 v[192:207], v[80:83], v[128:135], v236
  v_exp_f32 v139, v139
  v_exp_f32 v140, v140
  v_exp_f32 v141, v141
  v_lshlrev_b32 v246, 11, v246
  v_lshl_add_u32 v246, v247, 4, v246
  s_nop 0
  v_smfmac_f32_16x16x64_bf16 v[224:227], v[232:235], v[128:135], v236
  v_exp_f32 v142, v142
  v_exp_f32 v143, v143
  v_xor_b32 v247, 128, v246
  s_mov_b32 s58, 0x5f800000
  s_waitcnt lgkmcnt(0)
  v_mfma_f32_32x32x16_bf16 v[160:175], v[72:75], v[16:19], v[96:111]
  v_exp_f32 v144, v144
  v_exp_f32 v145, v145
  v_exp_f32 v146, v146
  s_lshl_b32 s7, s4, 3
  s_add_u32 s7, s7, s6
  s_lshl_b32 s7, s7, 2
  s_add_u32 s7, s7, s40
  ds_read_b128 v[64:67], v2 offset:8192
  ds_read_b128 v[68:71], v2 offset:9216
  v_mfma_f32_32x32x16_bf16 v[160:175], v[76:79], v[20:23], v[160:175]
  v_exp_f32 v147, v147
  v_exp_f32 v148, v148
  v_exp_f32 v149, v149
  s_lshl_b32 s49, s7, 8
  s_lshl_b32 s47, s7, 17
  s_bfe_u32 s7, s50, 0x50012
  s_lshl_b32 s51, s7, 3
  s_nop 0
  v_smfmac_f32_32x32x32_bf16 v[192:207], v[84:87], v[136:143], v236
  v_exp_f32 v150, v150
  v_exp_f32 v151, v151
  v_exp_f32 v152, v152
  s_add_u32 s49, s49, s51
  s_add_u32 s49, s49, 25231360
  s_lshl_b32 s7, s7, 11
  s_nop 0
  v_smfmac_f32_16x16x64_bf16 v[224:227], v[232:235], v[136:143], v236
  v_exp_f32 v153, v153
  v_exp_f32 v154, v154
  s_add_u32 s47, s47, s7
  s_add_u32 s47, s47, 16777216
  s_add_u32 s48, s47, 65536
  ds_read_b128 v[88:91], v2 offset:6144
  ds_read_b128 v[92:95], v2 offset:7168
  v_smfmac_f32_32x32x32_bf16 v[208:223], v[80:83], v[144:151], v236
  v_exp_f32 v155, v155
  v_exp_f32 v156, v156
  v_exp_f32 v157, v157
  v_and_b32 v10, 15, v0
  v_lshlrev_b32 v10, 4, v10
  v_lshrrev_b32 v11, 5, v0
  s_nop 0
  v_smfmac_f32_16x16x64_bf16 v[228:231], v[232:235], v[144:151], v236
  v_exp_f32 v158, v158
  v_exp_f32 v159, v159
  v_lshl_add_u32 v10, v11, 8, v10
  v_bfe_u32 v11, v0, 4, 1
  v_lshl_add_u32 v10, v11, 10, v10
  s_waitcnt lgkmcnt(0)
  v_mfma_f32_32x32x16_bf16 v[176:191], v[64:67], v[16:19], v[96:111]
  v_exp_f32 v160, v160
  v_exp_f32 v161, v161
  v_exp_f32 v162, v162
  ds_read_b128 v[72:75], v2 offset:12288
  ds_read_b128 v[76:79], v2 offset:13312
  v_mfma_f32_32x32x16_bf16 v[176:191], v[68:71], v[20:23], v[176:191]
  v_exp_f32 v163, v163
  v_exp_f32 v164, v164
  v_exp_f32 v165, v165
  s_mov_b32 m0, s46
  s_nop 0
  buffer_load_dwordx4 v246, s[8:11], s43 offen offset:0 sc1 lds
  s_add_u32 s43, s43, s44
  v_smfmac_f32_32x32x32_bf16 v[208:223], v[84:87], v[152:159], v236
  v_exp_f32 v166, v166
  v_exp_f32 v167, v167
  v_exp_f32 v168, v168
  s_nop 0
  v_smfmac_f32_16x16x64_bf16 v[228:231], v[232:235], v[152:159], v236
  v_exp_f32 v169, v169
  v_exp_f32 v170, v170
  ds_read_b128 v[80:83], v2 offset:10240
  ds_read_b128 v[84:87], v2 offset:11264
  v_smfmac_f32_32x32x32_bf16 v[192:207], v[88:91], v[160:167], v236
  v_exp_f32 v171, v171
  v_exp_f32 v172, v172
  v_exp_f32 v173, v173
  buffer_load_dwordx4 v247, s[8:11], s43 offen offset:1024 sc1 lds
  s_add_u32 s43, s43, s44
  v_smfmac_f32_16x16x64_bf16 v[224:227], v[232:235], v[160:167], v236
  v_exp_f32 v174, v174
  v_exp_f32 v175, v175
  s_waitcnt lgkmcnt(0)
  v_mfma_f32_32x32x16_bf16 v[128:143], v[72:75], v[16:19], v[96:111]
  v_exp_f32 v176, v176
  v_exp_f32 v177, v177
  v_exp_f32 v178, v178
  ds_read_b128 v[64:67], v2 offset:16384
  ds_read_b128 v[68:71], v2 offset:17408
  v_mfma_f32_32x32x16_bf16 v[128:143], v[76:79], v[20:23], v[128:143]
  v_exp_f32 v179, v179
  v_exp_f32 v180, v180
  v_exp_f32 v181, v181
  buffer_load_dwordx4 v246, s[8:11], s43 offen offset:2048 sc1 lds
  s_add_u32 s43, s43, s44
  v_smfmac_f32_32x32x32_bf16 v[192:207], v[92:95], v[168:175], v236
  v_exp_f32 v182, v182
  v_exp_f32 v183, v183
  v_exp_f32 v184, v184
  s_nop 0
  v_smfmac_f32_16x16x64_bf16 v[224:227], v[232:235], v[168:175], v236
  v_exp_f32 v185, v185
  v_exp_f32 v186, v186
  ds_read_b128 v[88:91], v2 offset:14336
  ds_read_b128 v[92:95], v2 offset:15360
  v_smfmac_f32_32x32x32_bf16 v[192:207], v[80:83], v[176:183], v236
  v_exp_f32 v187, v187
  v_exp_f32 v188, v188
  v_exp_f32 v189, v189
  buffer_load_dwordx4 v247, s[8:11], s43 offen offset:3072 sc1 lds
  s_add_u32 m0, s46, 4096
  s_mov_b32 s43, s45
  v_smfmac_f32_16x16x64_bf16 v[224:227], v[232:235], v[176:183], v236
  v_exp_f32 v190, v190
  v_exp_f32 v191, v191
  s_waitcnt lgkmcnt(0)
  v_mfma_f32_32x32x16_bf16 v[144:159], v[64:67], v[16:19], v[96:111]
  v_exp_f32 v128, v128
  v_exp_f32 v129, v129
  v_exp_f32 v130, v130
  ds_read_b128 v[72:75], v2 offset:20480
  ds_read_b128 v[76:79], v2 offset:21504
  v_mfma_f32_32x32x16_bf16 v[144:159], v[68:71], v[20:23], v[144:159]
  v_exp_f32 v131, v131
  v_exp_f32 v132, v132
  v_exp_f32 v133, v133
  buffer_load_dwordx4 v246, s[8:11], s43 offen offset:0 sc1 lds
  s_add_u32 s43, s43, s44
  v_smfmac_f32_32x32x32_bf16 v[192:207], v[84:87], v[184:191], v236
  v_exp_f32 v134, v134
  v_exp_f32 v135, v135
  v_exp_f32 v136, v136
  s_nop 0
  v_smfmac_f32_16x16x64_bf16 v[224:227], v[232:235], v[184:191], v236
  v_exp_f32 v137, v137
  v_exp_f32 v138, v138
  ds_read_b128 v[80:83], v2 offset:18432
  ds_read_b128 v[84:87], v2 offset:19456
  v_smfmac_f32_32x32x32_bf16 v[192:207], v[88:91], v[128:135], v236
  v_exp_f32 v139, v139
  v_exp_f32 v140, v140
  v_exp_f32 v141, v141
  buffer_load_dwordx4 v247, s[8:11], s43 offen offset:1024 sc1 lds
  s_add_u32 s43, s43, s44
  v_smfmac_f32_16x16x64_bf16 v[224:227], v[232:235], v[128:135], v236
  v_exp_f32 v142, v142
  v_exp_f32 v143, v143
  s_waitcnt lgkmcnt(0)
  v_mfma_f32_32x32x16_bf16 v[160:175], v[72:75], v[16:19], v[96:111]
  v_exp_f32 v144, v144
  v_exp_f32 v145, v145
  v_exp_f32 v146, v146
  ds_read_b128 v[64:67], v2 offset:24576
  ds_read_b128 v[68:71], v2 offset:25600
  v_mfma_f32_32x32x16_bf16 v[160:175], v[76:79], v[20:23], v[160:175]
  v_exp_f32 v147, v147
  v_exp_f32 v148, v148
  v_exp_f32 v149, v149
  buffer_load_dwordx4 v246, s[8:11], s43 offen offset:2048 sc1 lds
  s_add_u32 s43, s43, s44
  v_smfmac_f32_32x32x32_bf16 v[192:207], v[92:95], v[136:143], v236
  v_exp_f32 v150, v150
  v_exp_f32 v151, v151
  v_exp_f32 v152, v152
  s_nop 0
  v_smfmac_f32_16x16x64_bf16 v[224:227], v[232:235], v[136:143], v236
  v_exp_f32 v153, v153
  v_exp_f32 v154, v154
  ds_read_b128 v[88:91], v2 offset:22528
  ds_read_b128 v[92:95], v2 offset:23552
  v_smfmac_f32_32x32x32_bf16 v[192:207], v[80:83], v[144:151], v236
  v_exp_f32 v155, v155
  v_exp_f32 v156, v156
  v_exp_f32 v157, v157
  buffer_load_dwordx4 v247, s[8:11], s43 offen offset:3072 sc1 lds
  s_xor_b32 s46, s46, 65536
  v_smfmac_f32_16x16x64_bf16 v[224:227], v[232:235], v[144:151], v236
  v_exp_f32 v158, v158
  v_exp_f32 v159, v159
  s_waitcnt lgkmcnt(0)
  v_mfma_f32_32x32x16_bf16 v[176:191], v[64:67], v[16:19], v[96:111]
  v_exp_f32 v160, v160
  v_exp_f32 v161, v161
  v_exp_f32 v162, v162
  ds_read_b128 v[72:75], v2 offset:28672
  ds_read_b128 v[76:79], v2 offset:29696
  v_mfma_f32_32x32x16_bf16 v[176:191], v[68:71], v[20:23], v[176:191]
  v_exp_f32 v163, v163
  v_exp_f32 v164, v164
  v_exp_f32 v165, v165
  s_lshl_b32 s7, s3, 12
  s_add_u32 m0, s7, 131072
  s_lshl_b32 s43, s3, 15
  s_add_u32 s43, s43, 524288
  v_smfmac_f32_32x32x32_bf16 v[192:207], v[84:87], v[152:159], v236
  v_exp_f32 v166, v166
  v_exp_f32 v167, v167
  v_exp_f32 v168, v168
  buffer_load_dwordx4 v246, s[8:11], s43 offen offset:0 lds
  s_add_u32 s43, s43, s44
  v_smfmac_f32_16x16x64_bf16 v[224:227], v[232:235], v[152:159], v236
  v_exp_f32 v169, v169
  v_exp_f32 v170, v170
  ds_read_b128 v[80:83], v2 offset:26624
  ds_read_b128 v[84:87], v2 offset:27648
  v_smfmac_f32_32x32x32_bf16 v[192:207], v[88:91], v[160:167], v236
  v_exp_f32 v171, v171
  v_exp_f32 v172, v172
  v_exp_f32 v173, v173
  buffer_load_dwordx4 v247, s[8:11], s43 offen offset:1024 lds
  s_add_u32 s43, s43, s44
  v_smfmac_f32_16x16x64_bf16 v[224:227], v[232:235], v[160:167], v236
  v_exp_f32 v174, v174
  v_exp_f32 v175, v175
  s_waitcnt lgkmcnt(0)
  v_mfma_f32_32x32x16_bf16 v[128:143], v[72:75], v[16:19], v[96:111]
  v_exp_f32 v176, v176
  v_exp_f32 v177, v177
  v_exp_f32 v178, v178
  ds_read_b128 v[64:67], v2 offset:4096
  ds_read_b128 v[68:71], v2 offset:5120
  v_mfma_f32_32x32x16_bf16 v[128:143], v[76:79], v[20:23], v[128:143]
  v_exp_f32 v179, v179
  v_exp_f32 v180, v180
  v_exp_f32 v181, v181
  s_nop 0
  v_smfmac_f32_32x32x32_bf16 v[192:207], v[92:95], v[168:175], v236
  v_exp_f32 v182, v182
  v_exp_f32 v183, v183
  v_exp_f32 v184, v184
  buffer_load_dwordx4 v246, s[8:11], s43 offen offset:2048 lds
  s_add_u32 s43, s43, s44
  v_smfmac_f32_16x16x64_bf16 v[224:227], v[232:235], v[168:175], v236
  v_exp_f32 v185, v185
  v_exp_f32 v186, v186
  ds_read_b128 v[88:91], v2 offset:30720
  ds_read_b128 v[92:95], v2 offset:31744
  v_smfmac_f32_32x32x32_bf16 v[192:207], v[80:83], v[176:183], v236
  v_exp_f32 v187, v187
  v_exp_f32 v188, v188
  v_exp_f32 v189, v189
  buffer_load_dwordx4 v247, s[8:11], s43 offen offset:3072 lds
  s_add_u32 s43, s43, s44
  v_smfmac_f32_16x16x64_bf16 v[224:227], v[232:235], v[176:183], v236
  v_exp_f32 v190, v190
  v_exp_f32 v191, v191
  s_waitcnt lgkmcnt(0)
  v_mfma_f32_32x32x16_bf16 v[144:159], v[64:67], v[24:27], v[112:127]
  v_exp_f32 v128, v128
  v_exp_f32 v129, v129
  v_exp_f32 v130, v130
  s_bfe_u32 s56, s3, 0x10001
  s_and_b32 s57, s3, 1
  s_lshl_b32 s7, s4, 4
  ds_read_b128 v[72:75], v2 offset:8192
  ds_read_b128 v[76:79], v2 offset:9216
  v_mfma_f32_32x32x16_bf16 v[144:159], v[68:71], v[28:31], v[144:159]
  v_exp_f32 v131, v131
  v_exp_f32 v132, v132
  v_exp_f32 v133, v133
  s_add_u32 s7, s7, s5
  s_lshl_b32 s7, s7, 2
  s_add_u32 s7, s7, s40
  s_nop 0
  v_smfmac_f32_32x32x32_bf16 v[192:207], v[84:87], v[184:191], v236
  v_exp_f32 v134, v134
  v_exp_f32 v135, v135
  v_exp_f32 v136, v136
  s_lshr_b32 s100, s7, 1
  s_lshl_b32 s100, s100, 8
  s_add_u32 s100, s100, 25231360
  s_nop 0
  v_smfmac_f32_16x16x64_bf16 v[224:227], v[232:235], v[184:191], v236
  v_exp_f32 v137, v137
  v_exp_f32 v138, v138
  s_lshl_b32 s7, s7, 16
  s_add_u32 s7, s7, 16777216
  s_add_u32 s60, s32, s7
  ds_read_b128 v[80:83], v2 offset:6144
  ds_read_b128 v[84:87], v2 offset:7168
  v_smfmac_f32_32x32x32_bf16 v[192:207], v[88:91], v[128:135], v236
  v_exp_f32 v139, v139
  v_exp_f32 v140, v140
  v_exp_f32 v141, v141
  s_addc_u32 s61, s33, 0
  s_lshl_b32 s53, s40, 12
  s_lshl_b32 s59, s40, 15
  s_nop 0
  v_smfmac_f32_16x16x64_bf16 v[224:227], v[232:235], v[128:135], v236
  v_exp_f32 v142, v142
  v_exp_f32 v143, v143
  s_add_u32 s59, s59, 786432
  s_cmp_eq_u32 s41, 0
  s_cselect_b64 vcc, -1, 0
  s_waitcnt lgkmcnt(0)
  v_mfma_f32_32x32x16_bf16 v[160:175], v[72:75], v[24:27], v[112:127]
  v_exp_f32 v144, v144
  v_exp_f32 v145, v145
  v_exp_f32 v146, v146
  s_cselect_b32 s8, s60, s12
  s_cselect_b32 s9, s61, s13
  s_cselect_b32 s10, 0x10000, s14
  ds_read_b128 v[64:67], v2 offset:12288
  ds_read_b128 v[68:71], v2 offset:13312
  v_mfma_f32_32x32x16_bf16 v[160:175], v[76:79], v[28:31], v[160:175]
  v_exp_f32 v147, v147
  v_exp_f32 v148, v148
  v_exp_f32 v149, v149
  s_cselect_b32 s59, 0, s59
  s_cselect_b32 s44, 0, 7168
  s_cselect_b32 s52, 12, 17
  s_nop 0
  v_smfmac_f32_32x32x32_bf16 v[192:207], v[92:95], v[136:143], v236
  v_exp_f32 v150, v150
  v_exp_f32 v151, v151
  v_exp_f32 v152, v152
  s_lshl_b32 s52, 1, s52
  v_lshlrev_b32 v8, 4, v0
  v_cndmask_b32 v246, v246, v8, vcc
  s_nop 0
  v_smfmac_f32_16x16x64_bf16 v[224:227], v[232:235], v[136:143], v236
  v_exp_f32 v153, v153
  v_exp_f32 v154, v154
  v_cndmask_b32 v247, v247, v8, vcc
  s_lshl_b32 s7, s56, 1
  s_add_u32 s7, s7, s41
  ds_read_b128 v[88:91], v2 offset:10240
  ds_read_b128 v[92:95], v2 offset:11264
  v_smfmac_f32_32x32x32_bf16 v[208:223], v[80:83], v[144:151], v236
  v_exp_f32 v155, v155
  v_exp_f32 v156, v156
  v_exp_f32 v157, v157
  s_lshl_b32 s7, s7, 1
  s_add_u32 s7, s7, s41
  s_lshl_b32 s7, s7, 11
  s_nop 0
  v_smfmac_f32_16x16x64_bf16 v[228:231], v[232:235], v[144:151], v236
  v_exp_f32 v158, v158
  v_exp_f32 v159, v159
  s_add_u32 s7, s7, 65536
  v_add_u32 v244, s7, v8
  v_xor_b32 v245, 4096, v244
  s_waitcnt lgkmcnt(0)
  v_mfma_f32_32x32x16_bf16 v[176:191], v[64:67], v[24:27], v[112:127]
  v_exp_f32 v160, v160
  v_exp_f32 v161, v161
  v_exp_f32 v162, v162
  v_mov_b32 v225, v224
  s_nop 1
  v_permlane32_swap_b32 v224, v225
  ds_read_b128 v[72:75], v2 offset:16384
  ds_read_b128 v[76:79], v2 offset:17408
  v_mfma_f32_32x32x16_bf16 v[176:191], v[68:71], v[28:31], v[176:191]
  v_exp_f32 v163, v163
  v_exp_f32 v164, v164
  v_exp_f32 v165, v165
  v_pk_mul_f32 v[4:5], v[192:193], 0
  v_pk_fma_f32 v[4:5], v[194:195], 0, v[4:5]
  v_pk_fma_f32 v[4:5], v[196:197], 0, v[4:5]
  s_nop 0
  v_smfmac_f32_32x32x32_bf16 v[208:223], v[84:87], v[152:159], v236
  v_exp_f32 v166, v166
  v_exp_f32 v167, v167
  v_exp_f32 v168, v168
  v_pk_fma_f32 v[4:5], v[198:199], 0, v[4:5]
  v_pk_fma_f32 v[4:5], v[200:201], 0, v[4:5]
  s_nop 0
  v_smfmac_f32_16x16x64_bf16 v[228:231], v[232:235], v[152:159], v236
  v_exp_f32 v169, v169
  v_exp_f32 v170, v170
  v_pk_fma_f32 v[4:5], v[202:203], 0, v[4:5]
  v_pk_fma_f32 v[4:5], v[204:205], 0, v[4:5]
  ds_read_b128 v[80:83], v2 offset:14336
  ds_read_b128 v[84:87], v2 offset:15360
  v_smfmac_f32_32x32x32_bf16 v[208:223], v[88:91], v[160:167], v236
  v_exp_f32 v171, v171
  v_exp_f32 v172, v172
  v_exp_f32 v173, v173
  v_pk_fma_f32 v[4:5], v[206:207], 0, v[4:5]
  v_add_f32 v4, v4, v5
  s_nop 0
  v_smfmac_f32_16x16x64_bf16 v[228:231], v[232:235], v[160:167], v236
  v_exp_f32 v174, v174
  v_exp_f32 v175, v175
  v_add_f32 v4, v4, v224
  v_cmp_gt_f32 s[60:61], s58, v4
  s_waitcnt lgkmcnt(0)
  v_mfma_f32_32x32x16_bf16 v[128:143], v[72:75], v[24:27], v[112:127]
  v_exp_f32 v176, v176
  v_exp_f32 v177, v177
  v_exp_f32 v178, v178
  v_rcp_f32 v4, v224
  s_nop 0
  v_pk_mul_f32 v[192:193], v[192:193], v[4:5] op_sel_hi:[1,0]
  v_pk_mul_f32 v[194:195], v[194:195], v[4:5] op_sel_hi:[1,0]
  ds_read_b128 v[64:67], v2 offset:20480
  ds_read_b128 v[68:71], v2 offset:21504
  v_mfma_f32_32x32x16_bf16 v[128:143], v[76:79], v[28:31], v[128:143]
  v_exp_f32 v179, v179
  v_exp_f32 v180, v180
  v_exp_f32 v181, v181
  v_pk_mul_f32 v[196:197], v[196:197], v[4:5] op_sel_hi:[1,0]
  v_pk_mul_f32 v[198:199], v[198:199], v[4:5] op_sel_hi:[1,0]
  v_pk_mul_f32 v[200:201], v[200:201], v[4:5] op_sel_hi:[1,0]
  v_pk_mul_f32 v[202:203], v[202:203], v[4:5] op_sel_hi:[1,0]
  s_nop 0
  v_smfmac_f32_32x32x32_bf16 v[208:223], v[92:95], v[168:175], v236
  v_exp_f32 v182, v182
  v_exp_f32 v183, v183
  v_exp_f32 v184, v184
  v_pk_mul_f32 v[204:205], v[204:205], v[4:5] op_sel_hi:[1,0]
  v_pk_mul_f32 v[206:207], v[206:207], v[4:5] op_sel_hi:[1,0]
  v_cvt_pk_bf16_f32 v32, v192, v193
  s_nop 0
  v_smfmac_f32_16x16x64_bf16 v[228:231], v[232:235], v[168:175], v236
  v_exp_f32 v185, v185
  v_exp_f32 v186, v186
  v_cvt_pk_bf16_f32 v33, v194, v195
  v_cvt_pk_bf16_f32 v34, v196, v197
  v_cvt_pk_bf16_f32 v35, v198, v199
  ds_read_b128 v[88:91], v2 offset:18432
  ds_read_b128 v[92:95], v2 offset:19456
  v_smfmac_f32_32x32x32_bf16 v[208:223], v[80:83], v[176:183], v236
  v_exp_f32 v187, v187
  v_exp_f32 v188, v188
  v_exp_f32 v189, v189
  v_cvt_pk_bf16_f32 v36, v200, v201
  v_cvt_pk_bf16_f32 v37, v202, v203
  v_cvt_pk_bf16_f32 v38, v204, v205
  s_nop 0
  v_smfmac_f32_16x16x64_bf16 v[228:231], v[232:235], v[176:183], v236
  v_exp_f32 v190, v190
  v_exp_f32 v191, v191
  v_cvt_pk_bf16_f32 v39, v206, v207
  buffer_store_dwordx4 v[32:35], v10, s[36:39], s47 offen offset:0 sc1
  buffer_store_dwordx4 v[36:39], v10, s[36:39], s47 offen offset:512 sc1
  s_waitcnt lgkmcnt(0)
  v_mfma_f32_32x32x16_bf16 v[144:159], v[64:67], v[24:27], v[112:127]
  v_exp_f32 v128, v128
  v_exp_f32 v129, v129
  v_exp_f32 v130, v130
  v_bfe_u32 v7, v0, 2, 3
  v_lshrrev_b32 v8, 5, v0
  v_lshl_add_u32 v8, v8, 4, v7
  s_lshl_b32 s7, s41, 5
  ds_read_b128 v[72:75], v2 offset:24576
  ds_read_b128 v[76:79], v2 offset:25600
  v_mfma_f32_32x32x16_bf16 v[144:159], v[68:71], v[28:31], v[144:159]
  v_exp_f32 v131, v131
  v_exp_f32 v132, v132
  v_exp_f32 v133, v133
  v_add_u32 v8, s7, v8
  v_lshlrev_b32 v8, 8, v8
  v_bfe_u32 v9, v0, 1, 1
  s_lshl_b32 s7, s57, 3
  s_nop 0
  v_smfmac_f32_32x32x32_bf16 v[208:223], v[84:87], v[184:191], v236
  v_exp_f32 v134, v134
  v_exp_f32 v135, v135
  v_exp_f32 v136, v136
  v_add_u32 v9, s7, v9
  v_lshlrev_b32 v7, 1, v7
  v_xor_b32 v9, v9, v7
  v_lshl_add_u32 v8, v9, 4, v8
  s_nop 0
  v_smfmac_f32_16x16x64_bf16 v[228:231], v[232:235], v[184:191], v236
  v_exp_f32 v137, v137
  v_exp_f32 v138, v138
  v_and_b32 v9, 1, v0
  v_lshl_add_u32 v248, v9, 3, v8
  v_and_b32 v240, 31, v0
  v_lshlrev_b32 v240, 3, v240
  ds_read_b128 v[80:83], v2 offset:22528
  ds_read_b128 v[84:87], v2 offset:23552
  v_smfmac_f32_32x32x32_bf16 v[208:223], v[88:91], v[128:135], v236
  v_exp_f32 v139, v139
  v_exp_f32 v140, v140
  v_exp_f32 v141, v141
  v_xor_b32 v249, 32, v248
  v_xor_b32 v250, 64, v248
  v_xor_b32 v251, 96, v248
  v_add_u32 v252, 0x20000, v248
  s_nop 0
  v_smfmac_f32_16x16x64_bf16 v[228:231], v[232:235], v[128:135], v236
  v_exp_f32 v142, v142
  v_exp_f32 v143, v143
  v_add_u32 v253, 0x20000, v249
  v_add_u32 v254, 0x20000, v250
  v_add_u32 v255, 0x20000, v251
  s_waitcnt lgkmcnt(0)
  v_mfma_f32_32x32x16_bf16 v[160:175], v[72:75], v[24:27], v[112:127]
  v_exp_f32 v144, v144
  v_exp_f32 v145, v145
  v_exp_f32 v146, v146
  ds_read_b128 v[64:67], v2 offset:28672
  ds_read_b128 v[68:71], v2 offset:29696
  v_mfma_f32_32x32x16_bf16 v[160:175], v[76:79], v[28:31], v[160:175]
  v_exp_f32 v147, v147
  v_exp_f32 v148, v148
  v_exp_f32 v149, v149
  s_nop 0
  v_smfmac_f32_32x32x32_bf16 v[208:223], v[92:95], v[136:143], v236
  v_exp_f32 v150, v150
  v_exp_f32 v151, v151
  v_exp_f32 v152, v152
  s_nop 0
  v_smfmac_f32_16x16x64_bf16 v[228:231], v[232:235], v[136:143], v236
  v_exp_f32 v153, v153
  v_exp_f32 v154, v154
  ds_read_b128 v[88:91], v2 offset:26624
  ds_read_b128 v[92:95], v2 offset:27648
  v_smfmac_f32_32x32x32_bf16 v[208:223], v[80:83], v[144:151], v236
  v_exp_f32 v155, v155
  v_exp_f32 v156, v156
  v_exp_f32 v157, v157
  s_nop 0
  v_smfmac_f32_16x16x64_bf16 v[228:231], v[232:235], v[144:151], v236
  v_exp_f32 v158, v158
  v_exp_f32 v159, v159
  s_waitcnt lgkmcnt(0)
  v_mfma_f32_32x32x16_bf16 v[176:191], v[64:67], v[24:27], v[112:127]
  v_exp_f32 v160, v160
  v_exp_f32 v161, v161
  v_exp_f32 v162, v162
  s_nop 0
  v_mfma_f32_32x32x16_bf16 v[176:191], v[68:71], v[28:31], v[176:191]
  v_exp_f32 v163, v163
  v_exp_f32 v164, v164
  v_exp_f32 v165, v165
  s_nop 0
  v_smfmac_f32_32x32x32_bf16 v[208:223], v[84:87], v[152:159], v236
  v_exp_f32 v166, v166
  v_exp_f32 v167, v167
  v_exp_f32 v168, v168
  s_nop 0
  v_smfmac_f32_16x16x64_bf16 v[228:231], v[232:235], v[152:159], v236
  v_exp_f32 v169, v169
  v_exp_f32 v170, v170
  ds_read_b128 v[80:83], v2 offset:30720
  ds_read_b128 v[84:87], v2 offset:31744
  v_smfmac_f32_32x32x32_bf16 v[208:223], v[88:91], v[160:167], v236
  v_exp_f32 v171, v171
  v_exp_f32 v172, v172
  v_exp_f32 v173, v173
  s_nop 0
  v_smfmac_f32_16x16x64_bf16 v[228:231], v[232:235], v[160:167], v236
  v_exp_f32 v174, v174
  v_exp_f32 v175, v175
  s_waitcnt lgkmcnt(0)
  v_exp_f32 v176, v176
  v_exp_f32 v177, v177
  v_exp_f32 v178, v178
  v_exp_f32 v179, v179
  v_exp_f32 v180, v180
  v_exp_f32 v181, v181
  s_nop 0
  v_smfmac_f32_32x32x32_bf16 v[208:223], v[92:95], v[168:175], v236
  v_exp_f32 v182, v182
  v_exp_f32 v183, v183
  v_exp_f32 v184, v184
  s_nop 0
  v_smfmac_f32_16x16x64_bf16 v[228:231], v[232:235], v[168:175], v236
  v_exp_f32 v185, v185
  v_exp_f32 v186, v186
  s_nop 0
  v_smfmac_f32_32x32x32_bf16 v[208:223], v[80:83], v[176:183], v236
  v_exp_f32 v187, v187
  v_exp_f32 v188, v188
  v_exp_f32 v189, v189
  s_nop 0
  v_smfmac_f32_16x16x64_bf16 v[228:231], v[232:235], v[176:183], v236
  v_exp_f32 v190, v190
  v_exp_f32 v191, v191
  s_nop 1
  v_smfmac_f32_32x32x32_bf16 v[208:223], v[84:87], v[184:191], v236
  v_smfmac_f32_16x16x64_bf16 v[228:231], v[232:235], v[184:191], v236
  s_nop 7
  s_nop 3
  v_mov_b32 v229, v228
  s_nop 1
  v_permlane32_swap_b32 v228, v229
  v_pk_mul_f32 v[6:7], v[208:209], 0
  v_pk_fma_f32 v[6:7], v[210:211], 0, v[6:7]
  v_pk_fma_f32 v[6:7], v[212:213], 0, v[6:7]
  v_pk_fma_f32 v[6:7], v[214:215], 0, v[6:7]
  v_pk_fma_f32 v[6:7], v[216:217], 0, v[6:7]
  v_pk_fma_f32 v[6:7], v[218:219], 0, v[6:7]
  v_pk_fma_f32 v[6:7], v[220:221], 0, v[6:7]
  v_pk_fma_f32 v[6:7], v[222:223], 0, v[6:7]
  v_add_f32 v6, v6, v7
  v_add_f32 v6, v6, v228
  v_cmp_gt_f32 s[62:63], s58, v6
  s_and_b64 vcc, s[60:61], s[62:63]
  s_cmp_eq_u64 vcc, exec
  s_cbranch_scc0 L_fallback
L_fin:
  v_rcp_f32 v6, v228
  s_nop 0
  v_pk_mul_f32 v[208:209], v[208:209], v[6:7] op_sel_hi:[1,0]
  v_pk_mul_f32 v[210:211], v[210:211], v[6:7] op_sel_hi:[1,0]
  v_pk_mul_f32 v[212:213], v[212:213], v[6:7] op_sel_hi:[1,0]
  v_pk_mul_f32 v[214:215], v[214:215], v[6:7] op_sel_hi:[1,0]
  v_pk_mul_f32 v[216:217], v[216:217], v[6:7] op_sel_hi:[1,0]
  v_pk_mul_f32 v[218:219], v[218:219], v[6:7] op_sel_hi:[1,0]
  v_pk_mul_f32 v[220:221], v[220:221], v[6:7] op_sel_hi:[1,0]
  v_pk_mul_f32 v[222:223], v[222:223], v[6:7] op_sel_hi:[1,0]
  v_cvt_pk_bf16_f32 v40, v208, v209
  v_cvt_pk_bf16_f32 v41, v210, v211
  v_cvt_pk_bf16_f32 v42, v212, v213
  v_cvt_pk_bf16_f32 v43, v214, v215
  v_cvt_pk_bf16_f32 v44, v216, v217
  v_cvt_pk_bf16_f32 v45, v218, v219
  v_cvt_pk_bf16_f32 v46, v220, v221
  v_cvt_pk_bf16_f32 v47, v222, v223
  buffer_store_dwordx4 v[40:43], v10, s[36:39], s48 offen offset:0 sc1
  buffer_store_dwordx4 v[44:47], v10, s[36:39], s48 offen offset:512 sc1
  s_barrier
  s_waitcnt vmcnt(0)
  s_mov_b64 exec, 1
  buffer_store_dwordx2 v[238:239], v237, s[36:39], s49 offen offset:0 sc1
  s_mov_b64 exec, -1
  s_cmp_lg_u32 s41, 0
  s_cbranch_scc1 L_p3go
  s_mov_b32 s7, 65536
  buffer_load_dwordx2 v[242:243], v240, s[36:39], s100 offen sc1
L_pollo:
  s_waitcnt vmcnt(0)
  v_cmp_eq_u64 vcc, s[34:35], v[242:243]
  s_cmp_eq_u64 vcc, exec
  s_cbranch_scc1 L_pollo_done
  s_sub_u32 s7, s7, 1
  s_cbranch_scc1 L_pollo_done
  s_sleep 8
  buffer_load_dwordx2 v[242:243], v240, s[36:39], s100 offen sc1
  s_branch L_pollo
L_pollo_done:
  s_add_u32 m0, s53, 65536
  s_mov_b32 s43, s59
  buffer_load_dwordx4 v246, s[8:11], s43 offen offset:0 sc1 lds
  s_add_u32 s43, s43, s44
  buffer_load_dwordx4 v247, s[8:11], s43 offen offset:1024 sc1 lds
  s_add_u32 s43, s43, s44
  buffer_load_dwordx4 v246, s[8:11], s43 offen offset:2048 sc1 lds
  s_add_u32 s43, s43, s44
  buffer_load_dwordx4 v247, s[8:11], s43 offen offset:3072 sc1 lds
  s_add_u32 s59, s59, s52
  s_add_u32 m0, s53, 81920
  s_mov_b32 s43, s59
  buffer_load_dwordx4 v246, s[8:11], s43 offen offset:0 sc1 lds
  s_add_u32 s43, s43, s44
  buffer_load_dwordx4 v247, s[8:11], s43 offen offset:1024 sc1 lds
  s_add_u32 s43, s43, s44
  buffer_load_dwordx4 v246, s[8:11], s43 offen offset:2048 sc1 lds
  s_add_u32 s43, s43, s44
  buffer_load_dwordx4 v247, s[8:11], s43 offen offset:3072 sc1 lds
  s_add_u32 s59, s59, s52
  s_add_u32 m0, s53, 98304
  s_mov_b32 s43, s59
  buffer_load_dwordx4 v246, s[8:11], s43 offen offset:0 sc1 lds
  s_add_u32 s43, s43, s44
  buffer_load_dwordx4 v247, s[8:11], s43 offen offset:1024 sc1 lds
  s_add_u32 s43, s43, s44
  buffer_load_dwordx4 v246, s[8:11], s43 offen offset:2048 sc1 lds
  s_add_u32 s43, s43, s44
  buffer_load_dwordx4 v247, s[8:11], s43 offen offset:3072 sc1 lds
  s_add_u32 s59, s59, s52
  s_add_u32 m0, s53, 114688
  s_mov_b32 s43, s59
  buffer_load_dwordx4 v246, s[8:11], s43 offen offset:0 sc1 lds
  s_add_u32 s43, s43, s44
  buffer_load_dwordx4 v247, s[8:11], s43 offen offset:1024 sc1 lds
  s_add_u32 s43, s43, s44
  buffer_load_dwordx4 v246, s[8:11], s43 offen offset:2048 sc1 lds
  s_add_u32 s43, s43, s44
  buffer_load_dwordx4 v247, s[8:11], s43 offen offset:3072 sc1 lds
  s_add_u32 s59, s59, s52
  s_waitcnt vmcnt(12)
L_p3go:
  s_barrier
  ds_read_b64_tr_b16 v[48:49], v248 offset:0
  ds_read_b64_tr_b16 v[50:51], v248 offset:2048
  ds_read_b128 v[16:19], v244 offset:0
  ds_read_b128 v[20:23], v244 offset:1024
  ds_read_b128 v[24:27], v245 offset:0
  ds_read_b128 v[28:31], v245 offset:1024
  ds_read_b64_tr_b16 v[52:53], v249 offset:0
  ds_read_b64_tr_b16 v[54:55], v249 offset:2048
  ds_read_b64_tr_b16 v[56:57], v250 offset:0
  ds_read_b64_tr_b16 v[58:59], v250 offset:2048
  ds_read_b64_tr_b16 v[60:61], v251 offset:0
  ds_read_b64_tr_b16 v[62:63], v251 offset:2048
  s_waitcnt vmcnt(8) lgkmcnt(0)
  s_barrier
  v_mfma_f32_16x16x32_bf16 v[80:83], v[48:51], v[16:19], 0
  ds_read_b64_tr_b16 v[64:65], v248 offset:16384
  s_cmp_eq_u32 s41, 0
  s_mov_b32 s7, 0
  s_cmov_b32 s7, 65536
  s_add_u32 m0, s53, s7
  s_mov_b32 s43, s59
  buffer_load_dwordx4 v246, s[8:11], s43 offen offset:0 sc1 lds
  s_add_u32 s43, s43, s44
  v_mfma_f32_16x16x32_bf16 v[84:87], v[52:55], v[16:19], 0
  ds_read_b64_tr_b16 v[66:67], v248 offset:18432
  v_mfma_f32_16x16x32_bf16 v[88:91], v[56:59], v[16:19], 0
  ds_read_b128 v[32:35], v244 offset:16384
  v_mfma_f32_16x16x32_bf16 v[92:95], v[60:63], v[16:19], 0
  ds_read_b128 v[36:39], v244 offset:17408
  v_mfma_f32_16x16x32_bf16 v[108:111], v[60:63], v[20:23], 0
  ds_read_b128 v[40:43], v245 offset:16384
  buffer_load_dwordx4 v247, s[8:11], s43 offen offset:1024 sc1 lds
  s_add_u32 s43, s43, s44
  v_mfma_f32_16x16x32_bf16 v[104:107], v[56:59], v[20:23], 0
  ds_read_b128 v[44:47], v245 offset:17408
  v_mfma_f32_16x16x32_bf16 v[100:103], v[52:55], v[20:23], 0
  ds_read_b64_tr_b16 v[68:69], v249 offset:16384
  v_mfma_f32_16x16x32_bf16 v[96:99], v[48:51], v[20:23], 0
  ds_read_b64_tr_b16 v[70:71], v249 offset:18432
  v_mfma_f32_16x16x32_bf16 v[112:115], v[48:51], v[24:27], 0
  ds_read_b64_tr_b16 v[72:73], v250 offset:16384
  buffer_load_dwordx4 v246, s[8:11], s43 offen offset:2048 sc1 lds
  s_add_u32 s43, s43, s44
  v_mfma_f32_16x16x32_bf16 v[116:119], v[52:55], v[24:27], 0
  ds_read_b64_tr_b16 v[74:75], v250 offset:18432
  v_mfma_f32_16x16x32_bf16 v[120:123], v[56:59], v[24:27], 0
  ds_read_b64_tr_b16 v[76:77], v251 offset:16384
  v_mfma_f32_16x16x32_bf16 v[124:127], v[60:63], v[24:27], 0
  ds_read_b64_tr_b16 v[78:79], v251 offset:18432
  v_mfma_f32_16x16x32_bf16 v[140:143], v[60:63], v[28:31], 0
  buffer_load_dwordx4 v247, s[8:11], s43 offen offset:3072 sc1 lds
  s_add_u32 s59, s59, s52
  v_mfma_f32_16x16x32_bf16 v[136:139], v[56:59], v[28:31], 0
  v_mfma_f32_16x16x32_bf16 v[132:135], v[52:55], v[28:31], 0
  v_mfma_f32_16x16x32_bf16 v[128:131], v[48:51], v[28:31], 0
  s_waitcnt vmcnt(8) lgkmcnt(0)
  s_barrier
  v_mfma_f32_16x16x32_bf16 v[80:83], v[64:67], v[32:35], v[80:83]
  ds_read_b64_tr_b16 v[48:49], v248 offset:32768
  s_cmp_eq_u32 s41, 0
  s_mov_b32 s7, 16384
  s_cmov_b32 s7, 81920
  s_add_u32 m0, s53, s7
  s_mov_b32 s43, s59
  buffer_load_dwordx4 v246, s[8:11], s43 offen offset:0 sc1 lds
  s_add_u32 s43, s43, s44
  v_mfma_f32_16x16x32_bf16 v[84:87], v[68:71], v[32:35], v[84:87]
  ds_read_b64_tr_b16 v[50:51], v248 offset:34816
  v_mfma_f32_16x16x32_bf16 v[88:91], v[72:75], v[32:35], v[88:91]
  ds_read_b128 v[16:19], v244 offset:32768
  v_mfma_f32_16x16x32_bf16 v[92:95], v[76:79], v[32:35], v[92:95]
  ds_read_b128 v[20:23], v244 offset:33792
  v_mfma_f32_16x16x32_bf16 v[108:111], v[76:79], v[36:39], v[108:111]
  ds_read_b128 v[24:27], v245 offset:32768
  buffer_load_dwordx4 v247, s[8:11], s43 offen offset:1024 sc1 lds
  s_add_u32 s43, s43, s44
  v_mfma_f32_16x16x32_bf16 v[104:107], v[72:75], v[36:39], v[104:107]
  ds_read_b128 v[28:31], v245 offset:33792
  v_mfma_f32_16x16x32_bf16 v[100:103], v[68:71], v[36:39], v[100:103]
  ds_read_b64_tr_b16 v[52:53], v249 offset:32768
  v_mfma_f32_16x16x32_bf16 v[96:99], v[64:67], v[36:39], v[96:99]
  ds_read_b64_tr_b16 v[54:55], v249 offset:34816
  v_mfma_f32_16x16x32_bf16 v[112:115], v[64:67], v[40:43], v[112:115]
  ds_read_b64_tr_b16 v[56:57], v250 offset:32768
  buffer_load_dwordx4 v246, s[8:11], s43 offen offset:2048 sc1 lds
  s_add_u32 s43, s43, s44
  v_mfma_f32_16x16x32_bf16 v[116:119], v[68:71], v[40:43], v[116:119]
  ds_read_b64_tr_b16 v[58:59], v250 offset:34816
  v_mfma_f32_16x16x32_bf16 v[120:123], v[72:75], v[40:43], v[120:123]
  ds_read_b64_tr_b16 v[60:61], v251 offset:32768
  v_mfma_f32_16x16x32_bf16 v[124:127], v[76:79], v[40:43], v[124:127]
  ds_read_b64_tr_b16 v[62:63], v251 offset:34816
  v_mfma_f32_16x16x32_bf16 v[140:143], v[76:79], v[44:47], v[140:143]
  buffer_load_dwordx4 v247, s[8:11], s43 offen offset:3072 sc1 lds
  s_add_u32 s59, s59, s52
  v_mfma_f32_16x16x32_bf16 v[136:139], v[72:75], v[44:47], v[136:139]
  v_mfma_f32_16x16x32_bf16 v[132:135], v[68:71], v[44:47], v[132:135]
  v_mfma_f32_16x16x32_bf16 v[128:131], v[64:67], v[44:47], v[128:131]
  s_waitcnt vmcnt(8) lgkmcnt(0)
  s_barrier
  v_mfma_f32_16x16x32_bf16 v[80:83], v[48:51], v[16:19], v[80:83]
  ds_read_b64_tr_b16 v[64:65], v248 offset:49152
  s_cmp_eq_u32 s41, 0
  s_mov_b32 s7, 32768
  s_cmov_b32 s7, 98304
  s_add_u32 m0, s53, s7
  s_mov_b32 s43, s59
  buffer_load_dwordx4 v246, s[8:11], s43 offen offset:0 sc1 lds
  s_add_u32 s43, s43, s44
  v_mfma_f32_16x16x32_bf16 v[84:87], v[52:55], v[16:19], v[84:87]
  ds_read_b64_tr_b16 v[66:67], v248 offset:51200
  v_mfma_f32_16x16x32_bf16 v[88:91], v[56:59], v[16:19], v[88:91]
  ds_read_b128 v[32:35], v244 offset:49152
  v_mfma_f32_16x16x32_bf16 v[92:95], v[60:63], v[16:19], v[92:95]
  ds_read_b128 v[36:39], v244 offset:50176
  v_mfma_f32_16x16x32_bf16 v[108:111], v[60:63], v[20:23], v[108:111]
  ds_read_b128 v[40:43], v245 offset:49152
  buffer_load_dwordx4 v247, s[8:11], s43 offen offset:1024 sc1 lds
  s_add_u32 s43, s43, s44
  v_mfma_f32_16x16x32_bf16 v[104:107], v[56:59], v[20:23], v[104:107]
  ds_read_b128 v[44:47], v245 offset:50176
  v_mfma_f32_16x16x32_bf16 v[100:103], v[52:55], v[20:23], v[100:103]
  ds_read_b64_tr_b16 v[68:69], v249 offset:49152
  v_mfma_f32_16x16x32_bf16 v[96:99], v[48:51], v[20:23], v[96:99]
  ds_read_b64_tr_b16 v[70:71], v249 offset:51200
  v_mfma_f32_16x16x32_bf16 v[112:115], v[48:51], v[24:27], v[112:115]
  ds_read_b64_tr_b16 v[72:73], v250 offset:49152
  buffer_load_dwordx4 v246, s[8:11], s43 offen offset:2048 sc1 lds
  s_add_u32 s43, s43, s44
  v_mfma_f32_16x16x32_bf16 v[116:119], v[52:55], v[24:27], v[116:119]
  ds_read_b64_tr_b16 v[74:75], v250 offset:51200
  v_mfma_f32_16x16x32_bf16 v[120:123], v[56:59], v[24:27], v[120:123]
  ds_read_b64_tr_b16 v[76:77], v251 offset:49152
  v_mfma_f32_16x16x32_bf16 v[124:127], v[60:63], v[24:27], v[124:127]
  ds_read_b64_tr_b16 v[78:79], v251 offset:51200
  v_mfma_f32_16x16x32_bf16 v[140:143], v[60:63], v[28:31], v[140:143]
  buffer_load_dwordx4 v247, s[8:11], s43 offen offset:3072 sc1 lds
  s_add_u32 s59, s59, s52
  v_mfma_f32_16x16x32_bf16 v[136:139], v[56:59], v[28:31], v[136:139]
  v_mfma_f32_16x16x32_bf16 v[132:135], v[52:55], v[28:31], v[132:135]
  v_mfma_f32_16x16x32_bf16 v[128:131], v[48:51], v[28:31], v[128:131]
  s_waitcnt vmcnt(8) lgkmcnt(0)
  s_barrier
  v_mfma_f32_16x16x32_bf16 v[80:83], v[64:67], v[32:35], v[80:83]
  ds_read_b64_tr_b16 v[48:49], v252 offset:0
  s_cmp_eq_u32 s41, 0
  s_mov_b32 s7, 49152
  s_cmov_b32 s7, 114688
  s_add_u32 m0, s53, s7
  s_mov_b32 s43, s59
  buffer_load_dwordx4 v246, s[8:11], s43 offen offset:0 sc1 lds
  s_add_u32 s43, s43, s44
  v_mfma_f32_16x16x32_bf16 v[84:87], v[68:71], v[32:35], v[84:87]
  ds_read_b64_tr_b16 v[50:51], v252 offset:2048
  v_mfma_f32_16x16x32_bf16 v[88:91], v[72:75], v[32:35], v[88:91]
  ds_read_b128 v[16:19], v244 offset:0
  v_mfma_f32_16x16x32_bf16 v[92:95], v[76:79], v[32:35], v[92:95]
  ds_read_b128 v[20:23], v244 offset:1024
  v_mfma_f32_16x16x32_bf16 v[108:111], v[76:79], v[36:39], v[108:111]
  ds_read_b128 v[24:27], v245 offset:0
  buffer_load_dwordx4 v247, s[8:11], s43 offen offset:1024 sc1 lds
  s_add_u32 s43, s43, s44
  v_mfma_f32_16x16x32_bf16 v[104:107], v[72:75], v[36:39], v[104:107]
  ds_read_b128 v[28:31], v245 offset:1024
  v_mfma_f32_16x16x32_bf16 v[100:103], v[68:71], v[36:39], v[100:103]
  ds_read_b64_tr_b16 v[52:53], v253 offset:0
  v_mfma_f32_16x16x32_bf16 v[96:99], v[64:67], v[36:39], v[96:99]
  ds_read_b64_tr_b16 v[54:55], v253 offset:2048
  v_mfma_f32_16x16x32_bf16 v[112:115], v[64:67], v[40:43], v[112:115]
  ds_read_b64_tr_b16 v[56:57], v254 offset:0
  buffer_load_dwordx4 v246, s[8:11], s43 offen offset:2048 sc1 lds
  s_add_u32 s43, s43, s44
  v_mfma_f32_16x16x32_bf16 v[116:119], v[68:71], v[40:43], v[116:119]
  ds_read_b64_tr_b16 v[58:59], v254 offset:2048
  v_mfma_f32_16x16x32_bf16 v[120:123], v[72:75], v[40:43], v[120:123]
  ds_read_b64_tr_b16 v[60:61], v255 offset:0
  v_mfma_f32_16x16x32_bf16 v[124:127], v[76:79], v[40:43], v[124:127]
  ds_read_b64_tr_b16 v[62:63], v255 offset:2048
  v_mfma_f32_16x16x32_bf16 v[140:143], v[76:79], v[44:47], v[140:143]
  buffer_load_dwordx4 v247, s[8:11], s43 offen offset:3072 sc1 lds
  s_add_u32 s59, s59, s52
  v_mfma_f32_16x16x32_bf16 v[136:139], v[72:75], v[44:47], v[136:139]
  v_mfma_f32_16x16x32_bf16 v[132:135], v[68:71], v[44:47], v[132:135]
  v_mfma_f32_16x16x32_bf16 v[128:131], v[64:67], v[44:47], v[128:131]
  s_waitcnt vmcnt(8) lgkmcnt(0)
  s_barrier
  v_mfma_f32_16x16x32_bf16 v[80:83], v[48:51], v[16:19], v[80:83]
  ds_read_b64_tr_b16 v[64:65], v252 offset:16384
  s_cmp_eq_u32 s41, 0
  s_mov_b32 s7, 131072
  s_cmov_b32 s7, 65536
  s_add_u32 m0, s53, s7
  s_mov_b32 s43, s59
  buffer_load_dwordx4 v246, s[8:11], s43 offen offset:0 sc1 lds
  s_add_u32 s43, s43, s44
  v_mfma_f32_16x16x32_bf16 v[84:87], v[52:55], v[16:19], v[84:87]
  ds_read_b64_tr_b16 v[66:67], v252 offset:18432
  v_mfma_f32_16x16x32_bf16 v[88:91], v[56:59], v[16:19], v[88:91]
  ds_read_b128 v[32:35], v244 offset:16384
  v_mfma_f32_16x16x32_bf16 v[92:95], v[60:63], v[16:19], v[92:95]
  ds_read_b128 v[36:39], v244 offset:17408
  v_mfma_f32_16x16x32_bf16 v[108:111], v[60:63], v[20:23], v[108:111]
  ds_read_b128 v[40:43], v245 offset:16384
  buffer_load_dwordx4 v247, s[8:11], s43 offen offset:1024 sc1 lds
  s_add_u32 s43, s43, s44
  v_mfma_f32_16x16x32_bf16 v[104:107], v[56:59], v[20:23], v[104:107]
  ds_read_b128 v[44:47], v245 offset:17408
  v_mfma_f32_16x16x32_bf16 v[100:103], v[52:55], v[20:23], v[100:103]
  ds_read_b64_tr_b16 v[68:69], v253 offset:16384
  v_mfma_f32_16x16x32_bf16 v[96:99], v[48:51], v[20:23], v[96:99]
  ds_read_b64_tr_b16 v[70:71], v253 offset:18432
  v_mfma_f32_16x16x32_bf16 v[112:115], v[48:51], v[24:27], v[112:115]
  ds_read_b64_tr_b16 v[72:73], v254 offset:16384
  buffer_load_dwordx4 v246, s[8:11], s43 offen offset:2048 sc1 lds
  s_add_u32 s43, s43, s44
  v_mfma_f32_16x16x32_bf16 v[116:119], v[52:55], v[24:27], v[116:119]
  ds_read_b64_tr_b16 v[74:75], v254 offset:18432
  v_mfma_f32_16x16x32_bf16 v[120:123], v[56:59], v[24:27], v[120:123]
  ds_read_b64_tr_b16 v[76:77], v255 offset:16384
  v_mfma_f32_16x16x32_bf16 v[124:127], v[60:63], v[24:27], v[124:127]
  ds_read_b64_tr_b16 v[78:79], v255 offset:18432
  v_mfma_f32_16x16x32_bf16 v[140:143], v[60:63], v[28:31], v[140:143]
  buffer_load_dwordx4 v247, s[8:11], s43 offen offset:3072 sc1 lds
  s_add_u32 s59, s59, s52
  v_mfma_f32_16x16x32_bf16 v[136:139], v[56:59], v[28:31], v[136:139]
  v_mfma_f32_16x16x32_bf16 v[132:135], v[52:55], v[28:31], v[132:135]
  v_mfma_f32_16x16x32_bf16 v[128:131], v[48:51], v[28:31], v[128:131]
  s_waitcnt vmcnt(8) lgkmcnt(0)
  s_barrier
  v_mfma_f32_16x16x32_bf16 v[80:83], v[64:67], v[32:35], v[80:83]
  ds_read_b64_tr_b16 v[48:49], v248 offset:0
  s_cmp_eq_u32 s41, 0
  s_mov_b32 s7, 147456
  s_cmov_b32 s7, 81920
  s_add_u32 m0, s53, s7
  s_mov_b32 s43, s59
  buffer_load_dwordx4 v246, s[8:11], s43 offen offset:0 sc1 lds
  s_add_u32 s43, s43, s44
  v_mfma_f32_16x16x32_bf16 v[84:87], v[68:71], v[32:35], v[84:87]
  ds_read_b64_tr_b16 v[50:51], v248 offset:2048
  v_mfma_f32_16x16x32_bf16 v[88:91], v[72:75], v[32:35], v[88:91]
  ds_read_b128 v[16:19], v244 offset:32768
  v_mfma_f32_16x16x32_bf16 v[92:95], v[76:79], v[32:35], v[92:95]
  ds_read_b128 v[20:23], v244 offset:33792
  v_mfma_f32_16x16x32_bf16 v[108:111], v[76:79], v[36:39], v[108:111]
  ds_read_b128 v[24:27], v245 offset:32768
  buffer_load_dwordx4 v247, s[8:11], s43 offen offset:1024 sc1 lds
  s_add_u32 s43, s43, s44
  v_mfma_f32_16x16x32_bf16 v[104:107], v[72:75], v[36:39], v[104:107]
  ds_read_b128 v[28:31], v245 offset:33792
  v_mfma_f32_16x16x32_bf16 v[100:103], v[68:71], v[36:39], v[100:103]
  ds_read_b64_tr_b16 v[52:53], v249 offset:0
  v_mfma_f32_16x16x32_bf16 v[96:99], v[64:67], v[36:39], v[96:99]
  ds_read_b64_tr_b16 v[54:55], v249 offset:2048
  v_mfma_f32_16x16x32_bf16 v[112:115], v[64:67], v[40:43], v[112:115]
  ds_read_b64_tr_b16 v[56:57], v250 offset:0
  buffer_load_dwordx4 v246, s[8:11], s43 offen offset:2048 sc1 lds
  s_add_u32 s43, s43, s44
  v_mfma_f32_16x16x32_bf16 v[116:119], v[68:71], v[40:43], v[116:119]
  ds_read_b64_tr_b16 v[58:59], v250 offset:2048
  v_mfma_f32_16x16x32_bf16 v[120:123], v[72:75], v[40:43], v[120:123]
  ds_read_b64_tr_b16 v[60:61], v251 offset:0
  v_mfma_f32_16x16x32_bf16 v[124:127], v[76:79], v[40:43], v[124:127]
  ds_read_b64_tr_b16 v[62:63], v251 offset:2048
  v_mfma_f32_16x16x32_bf16 v[140:143], v[76:79], v[44:47], v[140:143]
  buffer_load_dwordx4 v247, s[8:11], s43 offen offset:3072 sc1 lds
  s_add_u32 s59, s59, s52
  v_mfma_f32_16x16x32_bf16 v[136:139], v[72:75], v[44:47], v[136:139]
  v_mfma_f32_16x16x32_bf16 v[132:135], v[68:71], v[44:47], v[132:135]
  v_mfma_f32_16x16x32_bf16 v[128:131], v[64:67], v[44:47], v[128:131]
  s_waitcnt vmcnt(8) lgkmcnt(0)
  s_barrier
  v_mfma_f32_16x16x32_bf16 v[80:83], v[48:51], v[16:19], v[80:83]
  ds_read_b64_tr_b16 v[64:65], v248 offset:16384
  s_cmp_eq_u32 s41, 0
  s_mov_b32 s7, 0
  s_cmov_b32 s7, 98304
  s_add_u32 m0, s53, s7
  s_mov_b32 s43, s59
  buffer_load_dwordx4 v246, s[8:11], s43 offen offset:0 sc1 lds
  s_add_u32 s43, s43, s44
  v_mfma_f32_16x16x32_bf16 v[84:87], v[52:55], v[16:19], v[84:87]
  ds_read_b64_tr_b16 v[66:67], v248 offset:18432
  v_mfma_f32_16x16x32_bf16 v[88:91], v[56:59], v[16:19], v[88:91]
  ds_read_b128 v[32:35], v244 offset:49152
  v_mfma_f32_16x16x32_bf16 v[92:95], v[60:63], v[16:19], v[92:95]
  ds_read_b128 v[36:39], v244 offset:50176
  v_mfma_f32_16x16x32_bf16 v[108:111], v[60:63], v[20:23], v[108:111]
  ds_read_b128 v[40:43], v245 offset:49152
  buffer_load_dwordx4 v247, s[8:11], s43 offen offset:1024 sc1 lds
  s_add_u32 s43, s43, s44
  v_mfma_f32_16x16x32_bf16 v[104:107], v[56:59], v[20:23], v[104:107]
  ds_read_b128 v[44:47], v245 offset:50176
  v_mfma_f32_16x16x32_bf16 v[100:103], v[52:55], v[20:23], v[100:103]
  ds_read_b64_tr_b16 v[68:69], v249 offset:16384
  v_mfma_f32_16x16x32_bf16 v[96:99], v[48:51], v[20:23], v[96:99]
  ds_read_b64_tr_b16 v[70:71], v249 offset:18432
  v_mfma_f32_16x16x32_bf16 v[112:115], v[48:51], v[24:27], v[112:115]
  ds_read_b64_tr_b16 v[72:73], v250 offset:16384
  buffer_load_dwordx4 v246, s[8:11], s43 offen offset:2048 sc1 lds
  s_add_u32 s43, s43, s44
  v_mfma_f32_16x16x32_bf16 v[116:119], v[52:55], v[24:27], v[116:119]
  ds_read_b64_tr_b16 v[74:75], v250 offset:18432
  v_mfma_f32_16x16x32_bf16 v[120:123], v[56:59], v[24:27], v[120:123]
  ds_read_b64_tr_b16 v[76:77], v251 offset:16384
  v_mfma_f32_16x16x32_bf16 v[124:127], v[60:63], v[24:27], v[124:127]
  ds_read_b64_tr_b16 v[78:79], v251 offset:18432
  v_mfma_f32_16x16x32_bf16 v[140:143], v[60:63], v[28:31], v[140:143]
  buffer_load_dwordx4 v247, s[8:11], s43 offen offset:3072 sc1 lds
  s_add_u32 s59, s59, s52
  v_mfma_f32_16x16x32_bf16 v[136:139], v[56:59], v[28:31], v[136:139]
  v_mfma_f32_16x16x32_bf16 v[132:135], v[52:55], v[28:31], v[132:135]
  v_mfma_f32_16x16x32_bf16 v[128:131], v[48:51], v[28:31], v[128:131]
  s_waitcnt vmcnt(8) lgkmcnt(0)
  s_barrier
  v_mfma_f32_16x16x32_bf16 v[80:83], v[64:67], v[32:35], v[80:83]
  ds_read_b64_tr_b16 v[48:49], v248 offset:32768
  s_cmp_eq_u32 s41, 0
  s_mov_b32 s7, 16384
  s_cmov_b32 s7, 114688
  s_add_u32 m0, s53, s7
  s_mov_b32 s43, s59
  buffer_load_dwordx4 v246, s[8:11], s43 offen offset:0 sc1 lds
  s_add_u32 s43, s43, s44
  v_mfma_f32_16x16x32_bf16 v[84:87], v[68:71], v[32:35], v[84:87]
  ds_read_b64_tr_b16 v[50:51], v248 offset:34816
  v_mfma_f32_16x16x32_bf16 v[88:91], v[72:75], v[32:35], v[88:91]
  ds_read_b128 v[16:19], v244 offset:0
  v_mfma_f32_16x16x32_bf16 v[92:95], v[76:79], v[32:35], v[92:95]
  ds_read_b128 v[20:23], v244 offset:1024
  v_mfma_f32_16x16x32_bf16 v[108:111], v[76:79], v[36:39], v[108:111]
  ds_read_b128 v[24:27], v245 offset:0
  buffer_load_dwordx4 v247, s[8:11], s43 offen offset:1024 sc1 lds
  s_add_u32 s43, s43, s44
  v_mfma_f32_16x16x32_bf16 v[104:107], v[72:75], v[36:39], v[104:107]
  ds_read_b128 v[28:31], v245 offset:1024
  v_mfma_f32_16x16x32_bf16 v[100:103], v[68:71], v[36:39], v[100:103]
  ds_read_b64_tr_b16 v[52:53], v249 offset:32768
  v_mfma_f32_16x16x32_bf16 v[96:99], v[64:67], v[36:39], v[96:99]
  ds_read_b64_tr_b16 v[54:55], v249 offset:34816
  v_mfma_f32_16x16x32_bf16 v[112:115], v[64:67], v[40:43], v[112:115]
  ds_read_b64_tr_b16 v[56:57], v250 offset:32768
  buffer_load_dwordx4 v246, s[8:11], s43 offen offset:2048 sc1 lds
  s_add_u32 s43, s43, s44
  v_mfma_f32_16x16x32_bf16 v[116:119], v[68:71], v[40:43], v[116:119]
  ds_read_b64_tr_b16 v[58:59], v250 offset:34816
  v_mfma_f32_16x16x32_bf16 v[120:123], v[72:75], v[40:43], v[120:123]
  ds_read_b64_tr_b16 v[60:61], v251 offset:32768
  v_mfma_f32_16x16x32_bf16 v[124:127], v[76:79], v[40:43], v[124:127]
  ds_read_b64_tr_b16 v[62:63], v251 offset:34816
  v_mfma_f32_16x16x32_bf16 v[140:143], v[76:79], v[44:47], v[140:143]
  buffer_load_dwordx4 v247, s[8:11], s43 offen offset:3072 sc1 lds
  s_add_u32 s59, s59, s52
  v_mfma_f32_16x16x32_bf16 v[136:139], v[72:75], v[44:47], v[136:139]
  v_mfma_f32_16x16x32_bf16 v[132:135], v[68:71], v[44:47], v[132:135]
  v_mfma_f32_16x16x32_bf16 v[128:131], v[64:67], v[44:47], v[128:131]
  s_waitcnt vmcnt(8) lgkmcnt(0)
  s_barrier
  v_mfma_f32_16x16x32_bf16 v[80:83], v[48:51], v[16:19], v[80:83]
  ds_read_b64_tr_b16 v[64:65], v248 offset:49152
  s_cmp_eq_u32 s41, 0
  s_mov_b32 s7, 32768
  s_cmov_b32 s7, 65536
  s_add_u32 m0, s53, s7
  s_mov_b32 s43, s59
  buffer_load_dwordx4 v246, s[8:11], s43 offen offset:0 sc1 lds
  s_add_u32 s43, s43, s44
  v_mfma_f32_16x16x32_bf16 v[84:87], v[52:55], v[16:19], v[84:87]
  ds_read_b64_tr_b16 v[66:67], v248 offset:51200
  v_mfma_f32_16x16x32_bf16 v[88:91], v[56:59], v[16:19], v[88:91]
  ds_read_b128 v[32:35], v244 offset:16384
  v_mfma_f32_16x16x32_bf16 v[92:95], v[60:63], v[16:19], v[92:95]
  ds_read_b128 v[36:39], v244 offset:17408
  v_mfma_f32_16x16x32_bf16 v[108:111], v[60:63], v[20:23], v[108:111]
  ds_read_b128 v[40:43], v245 offset:16384
  buffer_load_dwordx4 v247, s[8:11], s43 offen offset:1024 sc1 lds
  s_add_u32 s43, s43, s44
  v_mfma_f32_16x16x32_bf16 v[104:107], v[56:59], v[20:23], v[104:107]
  ds_read_b128 v[44:47], v245 offset:17408
  v_mfma_f32_16x16x32_bf16 v[100:103], v[52:55], v[20:23], v[100:103]
  ds_read_b64_tr_b16 v[68:69], v249 offset:49152
  v_mfma_f32_16x16x32_bf16 v[96:99], v[48:51], v[20:23], v[96:99]
  ds_read_b64_tr_b16 v[70:71], v249 offset:51200
  v_mfma_f32_16x16x32_bf16 v[112:115], v[48:51], v[24:27], v[112:115]
  ds_read_b64_tr_b16 v[72:73], v250 offset:49152
  buffer_load_dwordx4 v246, s[8:11], s43 offen offset:2048 sc1 lds
  s_add_u32 s43, s43, s44
  v_mfma_f32_16x16x32_bf16 v[116:119], v[52:55], v[24:27], v[116:119]
  ds_read_b64_tr_b16 v[74:75], v250 offset:51200
  v_mfma_f32_16x16x32_bf16 v[120:123], v[56:59], v[24:27], v[120:123]
  ds_read_b64_tr_b16 v[76:77], v251 offset:49152
  v_mfma_f32_16x16x32_bf16 v[124:127], v[60:63], v[24:27], v[124:127]
  ds_read_b64_tr_b16 v[78:79], v251 offset:51200
  v_mfma_f32_16x16x32_bf16 v[140:143], v[60:63], v[28:31], v[140:143]
  buffer_load_dwordx4 v247, s[8:11], s43 offen offset:3072 sc1 lds
  s_add_u32 s59, s59, s52
  v_mfma_f32_16x16x32_bf16 v[136:139], v[56:59], v[28:31], v[136:139]
  v_mfma_f32_16x16x32_bf16 v[132:135], v[52:55], v[28:31], v[132:135]
  v_mfma_f32_16x16x32_bf16 v[128:131], v[48:51], v[28:31], v[128:131]
  s_waitcnt vmcnt(8) lgkmcnt(0)
  s_barrier
  v_mfma_f32_16x16x32_bf16 v[80:83], v[64:67], v[32:35], v[80:83]
  ds_read_b64_tr_b16 v[48:49], v252 offset:0
  s_cmp_eq_u32 s41, 0
  s_mov_b32 s7, 49152
  s_cmov_b32 s7, 81920
  s_add_u32 m0, s53, s7
  s_mov_b32 s43, s59
  buffer_load_dwordx4 v246, s[8:11], s43 offen offset:0 sc1 lds
  s_add_u32 s43, s43, s44
  v_mfma_f32_16x16x32_bf16 v[84:87], v[68:71], v[32:35], v[84:87]
  ds_read_b64_tr_b16 v[50:51], v252 offset:2048
  v_mfma_f32_16x16x32_bf16 v[88:91], v[72:75], v[32:35], v[88:91]
  ds_read_b128 v[16:19], v244 offset:32768
  v_mfma_f32_16x16x32_bf16 v[92:95], v[76:79], v[32:35], v[92:95]
  ds_read_b128 v[20:23], v244 offset:33792
  v_mfma_f32_16x16x32_bf16 v[108:111], v[76:79], v[36:39], v[108:111]
  ds_read_b128 v[24:27], v245 offset:32768
  buffer_load_dwordx4 v247, s[8:11], s43 offen offset:1024 sc1 lds
  s_add_u32 s43, s43, s44
  v_mfma_f32_16x16x32_bf16 v[104:107], v[72:75], v[36:39], v[104:107]
  ds_read_b128 v[28:31], v245 offset:33792
  v_mfma_f32_16x16x32_bf16 v[100:103], v[68:71], v[36:39], v[100:103]
  ds_read_b64_tr_b16 v[52:53], v253 offset:0
  v_mfma_f32_16x16x32_bf16 v[96:99], v[64:67], v[36:39], v[96:99]
  ds_read_b64_tr_b16 v[54:55], v253 offset:2048
  v_mfma_f32_16x16x32_bf16 v[112:115], v[64:67], v[40:43], v[112:115]
  ds_read_b64_tr_b16 v[56:57], v254 offset:0
  buffer_load_dwordx4 v246, s[8:11], s43 offen offset:2048 sc1 lds
  s_add_u32 s43, s43, s44
  v_mfma_f32_16x16x32_bf16 v[116:119], v[68:71], v[40:43], v[116:119]
  ds_read_b64_tr_b16 v[58:59], v254 offset:2048
  v_mfma_f32_16x16x32_bf16 v[120:123], v[72:75], v[40:43], v[120:123]
  ds_read_b64_tr_b16 v[60:61], v255 offset:0
  v_mfma_f32_16x16x32_bf16 v[124:127], v[76:79], v[40:43], v[124:127]
  ds_read_b64_tr_b16 v[62:63], v255 offset:2048
  v_mfma_f32_16x16x32_bf16 v[140:143], v[76:79], v[44:47], v[140:143]
  buffer_load_dwordx4 v247, s[8:11], s43 offen offset:3072 sc1 lds
  s_add_u32 s59, s59, s52
  v_mfma_f32_16x16x32_bf16 v[136:139], v[72:75], v[44:47], v[136:139]
  v_mfma_f32_16x16x32_bf16 v[132:135], v[68:71], v[44:47], v[132:135]
  v_mfma_f32_16x16x32_bf16 v[128:131], v[64:67], v[44:47], v[128:131]
  s_waitcnt vmcnt(8) lgkmcnt(0)
  s_barrier
  v_mfma_f32_16x16x32_bf16 v[80:83], v[48:51], v[16:19], v[80:83]
  ds_read_b64_tr_b16 v[64:65], v252 offset:16384
  s_cmp_eq_u32 s41, 0
  s_mov_b32 s7, 131072
  s_cmov_b32 s7, 98304
  s_add_u32 m0, s53, s7
  s_mov_b32 s43, s59
  buffer_load_dwordx4 v246, s[8:11], s43 offen offset:0 sc1 lds
  s_add_u32 s43, s43, s44
  v_mfma_f32_16x16x32_bf16 v[84:87], v[52:55], v[16:19], v[84:87]
  ds_read_b64_tr_b16 v[66:67], v252 offset:18432
  v_mfma_f32_16x16x32_bf16 v[88:91], v[56:59], v[16:19], v[88:91]
  ds_read_b128 v[32:35], v244 offset:49152
  v_mfma_f32_16x16x32_bf16 v[92:95], v[60:63], v[16:19], v[92:95]
  ds_read_b128 v[36:39], v244 offset:50176
  v_mfma_f32_16x16x32_bf16 v[108:111], v[60:63], v[20:23], v[108:111]
  ds_read_b128 v[40:43], v245 offset:49152
  buffer_load_dwordx4 v247, s[8:11], s43 offen offset:1024 sc1 lds
  s_add_u32 s43, s43, s44
  v_mfma_f32_16x16x32_bf16 v[104:107], v[56:59], v[20:23], v[104:107]
  ds_read_b128 v[44:47], v245 offset:50176
  v_mfma_f32_16x16x32_bf16 v[100:103], v[52:55], v[20:23], v[100:103]
  ds_read_b64_tr_b16 v[68:69], v253 offset:16384
  v_mfma_f32_16x16x32_bf16 v[96:99], v[48:51], v[20:23], v[96:99]
  ds_read_b64_tr_b16 v[70:71], v253 offset:18432
  v_mfma_f32_16x16x32_bf16 v[112:115], v[48:51], v[24:27], v[112:115]
  ds_read_b64_tr_b16 v[72:73], v254 offset:16384
  buffer_load_dwordx4 v246, s[8:11], s43 offen offset:2048 sc1 lds
  s_add_u32 s43, s43, s44
  v_mfma_f32_16x16x32_bf16 v[116:119], v[52:55], v[24:27], v[116:119]
  ds_read_b64_tr_b16 v[74:75], v254 offset:18432
  v_mfma_f32_16x16x32_bf16 v[120:123], v[56:59], v[24:27], v[120:123]
  ds_read_b64_tr_b16 v[76:77], v255 offset:16384
  v_mfma_f32_16x16x32_bf16 v[124:127], v[60:63], v[24:27], v[124:127]
  ds_read_b64_tr_b16 v[78:79], v255 offset:18432
  v_mfma_f32_16x16x32_bf16 v[140:143], v[60:63], v[28:31], v[140:143]
  buffer_load_dwordx4 v247, s[8:11], s43 offen offset:3072 sc1 lds
  s_add_u32 s59, s59, s52
  v_mfma_f32_16x16x32_bf16 v[136:139], v[56:59], v[28:31], v[136:139]
  v_mfma_f32_16x16x32_bf16 v[132:135], v[52:55], v[28:31], v[132:135]
  v_mfma_f32_16x16x32_bf16 v[128:131], v[48:51], v[28:31], v[128:131]
  s_waitcnt vmcnt(8) lgkmcnt(0)
  s_barrier
  v_mfma_f32_16x16x32_bf16 v[80:83], v[64:67], v[32:35], v[80:83]
  ds_read_b64_tr_b16 v[48:49], v248 offset:0
  s_cmp_eq_u32 s41, 0
  s_mov_b32 s7, 147456
  s_cmov_b32 s7, 114688
  s_add_u32 m0, s53, s7
  s_mov_b32 s43, s59
  buffer_load_dwordx4 v246, s[8:11], s43 offen offset:0 sc1 lds
  s_add_u32 s43, s43, s44
  v_mfma_f32_16x16x32_bf16 v[84:87], v[68:71], v[32:35], v[84:87]
  ds_read_b64_tr_b16 v[50:51], v248 offset:2048
  v_mfma_f32_16x16x32_bf16 v[88:91], v[72:75], v[32:35], v[88:91]
  ds_read_b128 v[16:19], v244 offset:0
  v_mfma_f32_16x16x32_bf16 v[92:95], v[76:79], v[32:35], v[92:95]
  ds_read_b128 v[20:23], v244 offset:1024
  v_mfma_f32_16x16x32_bf16 v[108:111], v[76:79], v[36:39], v[108:111]
  ds_read_b128 v[24:27], v245 offset:0
  buffer_load_dwordx4 v247, s[8:11], s43 offen offset:1024 sc1 lds
  s_add_u32 s43, s43, s44
  v_mfma_f32_16x16x32_bf16 v[104:107], v[72:75], v[36:39], v[104:107]
  ds_read_b128 v[28:31], v245 offset:1024
  v_mfma_f32_16x16x32_bf16 v[100:103], v[68:71], v[36:39], v[100:103]
  ds_read_b64_tr_b16 v[52:53], v249 offset:0
  v_mfma_f32_16x16x32_bf16 v[96:99], v[64:67], v[36:39], v[96:99]
  ds_read_b64_tr_b16 v[54:55], v249 offset:2048
  v_mfma_f32_16x16x32_bf16 v[112:115], v[64:67], v[40:43], v[112:115]
  ds_read_b64_tr_b16 v[56:57], v250 offset:0
  buffer_load_dwordx4 v246, s[8:11], s43 offen offset:2048 sc1 lds
  s_add_u32 s43, s43, s44
  v_mfma_f32_16x16x32_bf16 v[116:119], v[68:71], v[40:43], v[116:119]
  ds_read_b64_tr_b16 v[58:59], v250 offset:2048
  v_mfma_f32_16x16x32_bf16 v[120:123], v[72:75], v[40:43], v[120:123]
  ds_read_b64_tr_b16 v[60:61], v251 offset:0
  v_mfma_f32_16x16x32_bf16 v[124:127], v[76:79], v[40:43], v[124:127]
  ds_read_b64_tr_b16 v[62:63], v251 offset:2048
  v_mfma_f32_16x16x32_bf16 v[140:143], v[76:79], v[44:47], v[140:143]
  buffer_load_dwordx4 v247, s[8:11], s43 offen offset:3072 sc1 lds
  s_add_u32 s59, s59, s52
  v_mfma_f32_16x16x32_bf16 v[136:139], v[72:75], v[44:47], v[136:139]
  v_mfma_f32_16x16x32_bf16 v[132:135], v[68:71], v[44:47], v[132:135]
  v_mfma_f32_16x16x32_bf16 v[128:131], v[64:67], v[44:47], v[128:131]
  s_waitcnt vmcnt(8) lgkmcnt(0)
  s_barrier
  v_mfma_f32_16x16x32_bf16 v[80:83], v[48:51], v[16:19], v[80:83]
  ds_read_b64_tr_b16 v[64:65], v248 offset:16384
  v_mfma_f32_16x16x32_bf16 v[84:87], v[52:55], v[16:19], v[84:87]
  ds_read_b64_tr_b16 v[66:67], v248 offset:18432
  v_mfma_f32_16x16x32_bf16 v[88:91], v[56:59], v[16:19], v[88:91]
  ds_read_b128 v[32:35], v244 offset:16384
  v_mfma_f32_16x16x32_bf16 v[92:95], v[60:63], v[16:19], v[92:95]
  ds_read_b128 v[36:39], v244 offset:17408
  v_mfma_f32_16x16x32_bf16 v[108:111], v[60:63], v[20:23], v[108:111]
  ds_read_b128 v[40:43], v245 offset:16384
  v_mfma_f32_16x16x32_bf16 v[104:107], v[56:59], v[20:23], v[104:107]
  ds_read_b128 v[44:47], v245 offset:17408
  v_mfma_f32_16x16x32_bf16 v[100:103], v[52:55], v[20:23], v[100:103]
  ds_read_b64_tr_b16 v[68:69], v249 offset:16384
  v_mfma_f32_16x16x32_bf16 v[96:99], v[48:51], v[20:23], v[96:99]
  ds_read_b64_tr_b16 v[70:71], v249 offset:18432
  v_mfma_f32_16x16x32_bf16 v[112:115], v[48:51], v[24:27], v[112:115]
  ds_read_b64_tr_b16 v[72:73], v250 offset:16384
  v_mfma_f32_16x16x32_bf16 v[116:119], v[52:55], v[24:27], v[116:119]
  ds_read_b64_tr_b16 v[74:75], v250 offset:18432
  v_mfma_f32_16x16x32_bf16 v[120:123], v[56:59], v[24:27], v[120:123]
  ds_read_b64_tr_b16 v[76:77], v251 offset:16384
  v_mfma_f32_16x16x32_bf16 v[124:127], v[60:63], v[24:27], v[124:127]
  ds_read_b64_tr_b16 v[78:79], v251 offset:18432
  v_mfma_f32_16x16x32_bf16 v[140:143], v[60:63], v[28:31], v[140:143]
  v_mfma_f32_16x16x32_bf16 v[136:139], v[56:59], v[28:31], v[136:139]
  v_mfma_f32_16x16x32_bf16 v[132:135], v[52:55], v[28:31], v[132:135]
  v_mfma_f32_16x16x32_bf16 v[128:131], v[48:51], v[28:31], v[128:131]
  s_waitcnt vmcnt(4) lgkmcnt(0)
  s_barrier
  v_mfma_f32_16x16x32_bf16 v[80:83], v[64:67], v[32:35], v[80:83]
  ds_read_b64_tr_b16 v[48:49], v248 offset:32768
  v_mfma_f32_16x16x32_bf16 v[84:87], v[68:71], v[32:35], v[84:87]
  ds_read_b64_tr_b16 v[50:51], v248 offset:34816
  v_mfma_f32_16x16x32_bf16 v[88:91], v[72:75], v[32:35], v[88:91]
  ds_read_b128 v[16:19], v244 offset:32768
  v_mfma_f32_16x16x32_bf16 v[92:95], v[76:79], v[32:35], v[92:95]
  ds_read_b128 v[20:23], v244 offset:33792
  v_mfma_f32_16x16x32_bf16 v[108:111], v[76:79], v[36:39], v[108:111]
  ds_read_b128 v[24:27], v245 offset:32768
  v_mfma_f32_16x16x32_bf16 v[104:107], v[72:75], v[36:39], v[104:107]
  ds_read_b128 v[28:31], v245 offset:33792
  v_mfma_f32_16x16x32_bf16 v[100:103], v[68:71], v[36:39], v[100:103]
  ds_read_b64_tr_b16 v[52:53], v249 offset:32768
  v_mfma_f32_16x16x32_bf16 v[96:99], v[64:67], v[36:39], v[96:99]
  ds_read_b64_tr_b16 v[54:55], v249 offset:34816
  v_mfma_f32_16x16x32_bf16 v[112:115], v[64:67], v[40:43], v[112:115]
  ds_read_b64_tr_b16 v[56:57], v250 offset:32768
  v_mfma_f32_16x16x32_bf16 v[116:119], v[68:71], v[40:43], v[116:119]
  ds_read_b64_tr_b16 v[58:59], v250 offset:34816
  v_mfma_f32_16x16x32_bf16 v[120:123], v[72:75], v[40:43], v[120:123]
  ds_read_b64_tr_b16 v[60:61], v251 offset:32768
  v_mfma_f32_16x16x32_bf16 v[124:127], v[76:79], v[40:43], v[124:127]
  ds_read_b64_tr_b16 v[62:63], v251 offset:34816
  v_mfma_f32_16x16x32_bf16 v[140:143], v[76:79], v[44:47], v[140:143]
  v_mfma_f32_16x16x32_bf16 v[136:139], v[72:75], v[44:47], v[136:139]
  v_mfma_f32_16x16x32_bf16 v[132:135], v[68:71], v[44:47], v[132:135]
  v_mfma_f32_16x16x32_bf16 v[128:131], v[64:67], v[44:47], v[128:131]
  s_waitcnt vmcnt(0) lgkmcnt(0)
  s_barrier
  v_mfma_f32_16x16x32_bf16 v[80:83], v[48:51], v[16:19], v[80:83]
  ds_read_b64_tr_b16 v[64:65], v248 offset:49152
  s_lshl_b32 s7, s41, 3
  s_add_u32 s7, s7, s40
  v_mfma_f32_16x16x32_bf16 v[84:87], v[52:55], v[16:19], v[84:87]
  ds_read_b64_tr_b16 v[66:67], v248 offset:51200
  s_lshl_b32 s7, s7, 13
  v_lshlrev_b32 v176, 4, v0
  v_mfma_f32_16x16x32_bf16 v[88:91], v[56:59], v[16:19], v[88:91]
  ds_read_b128 v[32:35], v244 offset:49152
  v_add_u32 v176, s7, v176
  v_xor_b32 v177, 0x10000, v176
  v_mfma_f32_16x16x32_bf16 v[92:95], v[60:63], v[16:19], v[92:95]
  ds_read_b128 v[36:39], v244 offset:50176
  s_mov_b32 s12, s28
  s_mov_b32 s13, s29
  v_mfma_f32_16x16x32_bf16 v[108:111], v[60:63], v[20:23], v[108:111]
  ds_read_b128 v[40:43], v245 offset:49152
  s_mov_b32 s14, 0x800000
  s_lshl_b32 s7, s5, 2
  v_mfma_f32_16x16x32_bf16 v[104:107], v[56:59], v[20:23], v[104:107]
  ds_read_b128 v[44:47], v245 offset:50176
  s_lshl_b32 s43, s56, 1
  s_add_u32 s7, s7, s43
  v_mfma_f32_16x16x32_bf16 v[100:103], v[52:55], v[20:23], v[100:103]
  ds_read_b64_tr_b16 v[68:69], v249 offset:49152
  s_add_u32 s7, s7, s41
  s_lshl_b32 s7, s7, 17
  v_mfma_f32_16x16x32_bf16 v[96:99], v[48:51], v[20:23], v[96:99]
  ds_read_b64_tr_b16 v[70:71], v249 offset:51200
  s_lshl_b32 s43, s4, 11
  s_add_u32 s7, s7, s43
  v_mfma_f32_16x16x32_bf16 v[112:115], v[48:51], v[24:27], v[112:115]
  ds_read_b64_tr_b16 v[72:73], v250 offset:49152
  s_lshl_b32 s43, s6, 8
  s_add_u32 s7, s7, s43
  v_mfma_f32_16x16x32_bf16 v[116:119], v[52:55], v[24:27], v[116:119]
  ds_read_b64_tr_b16 v[74:75], v250 offset:51200
  s_lshl_b32 s43, s57, 7
  s_add_u32 s43, s7, s43
  v_mfma_f32_16x16x32_bf16 v[120:123], v[56:59], v[24:27], v[120:123]
  ds_read_b64_tr_b16 v[76:77], v251 offset:49152
  s_add_u32 s44, s43, 65536
  v_and_b32 v178, 15, v0
  v_mfma_f32_16x16x32_bf16 v[124:127], v[60:63], v[24:27], v[124:127]
  ds_read_b64_tr_b16 v[78:79], v251 offset:51200
  v_lshlrev_b32 v178, 12, v178
  v_bfe_u32 v179, v0, 4, 1
  v_mfma_f32_16x16x32_bf16 v[140:143], v[60:63], v[28:31], v[140:143]
  v_lshl_add_u32 v178, v179, 5, v178
  v_lshrrev_b32 v179, 5, v0
  v_mfma_f32_16x16x32_bf16 v[136:139], v[56:59], v[28:31], v[136:139]
  v_lshl_add_u32 v178, v179, 4, v178
  v_mfma_f32_16x16x32_bf16 v[132:135], v[52:55], v[28:31], v[132:135]
  v_mfma_f32_16x16x32_bf16 v[128:131], v[48:51], v[28:31], v[128:131]
  s_waitcnt lgkmcnt(0)
  v_mfma_f32_16x16x32_bf16 v[112:115], v[64:67], v[40:43], v[112:115]
  v_mfma_f32_16x16x32_bf16 v[128:131], v[64:67], v[44:47], v[128:131]
  v_mfma_f32_16x16x32_bf16 v[116:119], v[68:71], v[40:43], v[116:119]
  v_mfma_f32_16x16x32_bf16 v[132:135], v[68:71], v[44:47], v[132:135]
  v_mfma_f32_16x16x32_bf16 v[120:123], v[72:75], v[40:43], v[120:123]
  v_mfma_f32_16x16x32_bf16 v[136:139], v[72:75], v[44:47], v[136:139]
  v_mfma_f32_16x16x32_bf16 v[124:127], v[76:79], v[40:43], v[124:127]
  v_mfma_f32_16x16x32_bf16 v[140:143], v[76:79], v[44:47], v[140:143]
  v_mfma_f32_16x16x32_bf16 v[80:83], v[64:67], v[32:35], v[80:83]
  ds_write_b128 v176, v[112:115] offset:0
  v_mfma_f32_16x16x32_bf16 v[96:99], v[64:67], v[36:39], v[96:99]
  ds_write_b128 v176, v[128:131] offset:4096
  v_mfma_f32_16x16x32_bf16 v[84:87], v[68:71], v[32:35], v[84:87]
  ds_write_b128 v176, v[116:119] offset:1024
  v_mfma_f32_16x16x32_bf16 v[100:103], v[68:71], v[36:39], v[100:103]
  ds_write_b128 v176, v[132:135] offset:5120
  v_mfma_f32_16x16x32_bf16 v[88:91], v[72:75], v[32:35], v[88:91]
  ds_write_b128 v176, v[120:123] offset:2048
  v_mfma_f32_16x16x32_bf16 v[104:107], v[72:75], v[36:39], v[104:107]
  ds_write_b128 v176, v[136:139] offset:6144
  v_mfma_f32_16x16x32_bf16 v[92:95], v[76:79], v[32:35], v[92:95]
  ds_write_b128 v176, v[124:127] offset:3072
  v_mfma_f32_16x16x32_bf16 v[108:111], v[76:79], v[36:39], v[108:111]
  ds_write_b128 v176, v[140:143] offset:7168
  s_waitcnt lgkmcnt(0)
  s_barrier
  ds_read_b128 v[144:147], v177 offset:0
  ds_read_b128 v[148:151], v177 offset:1024
  ds_read_b128 v[152:155], v177 offset:2048
  ds_read_b128 v[156:159], v177 offset:3072
  ds_read_b128 v[160:163], v177 offset:4096
  ds_read_b128 v[164:167], v177 offset:5120
  ds_read_b128 v[168:171], v177 offset:6144
  ds_read_b128 v[172:175], v177 offset:7168
  s_waitcnt lgkmcnt(6)
  v_pk_add_f32 v[80:81], v[80:81], v[144:145]
  v_pk_add_f32 v[82:83], v[82:83], v[146:147]
  v_pk_add_f32 v[84:85], v[84:85], v[148:149]
  v_pk_add_f32 v[86:87], v[86:87], v[150:151]
  v_cvt_pk_bf16_f32 v16, v80, v81
  v_cvt_pk_bf16_f32 v17, v82, v83
  v_cvt_pk_bf16_f32 v18, v84, v85
  v_cvt_pk_bf16_f32 v19, v86, v87
  s_waitcnt lgkmcnt(4)
  v_pk_add_f32 v[88:89], v[88:89], v[152:153]
  v_pk_add_f32 v[90:91], v[90:91], v[154:155]
  v_pk_add_f32 v[92:93], v[92:93], v[156:157]
  v_pk_add_f32 v[94:95], v[94:95], v[158:159]
  v_cvt_pk_bf16_f32 v20, v88, v89
  v_cvt_pk_bf16_f32 v21, v90, v91
  v_cvt_pk_bf16_f32 v22, v92, v93
  v_cvt_pk_bf16_f32 v23, v94, v95
  v_permlane16_swap_b32 v16, v18
  v_permlane16_swap_b32 v17, v19
  buffer_store_dwordx4 v[16:19], v178, s[12:15], s43 offen offset:0 sc0 sc1
  s_waitcnt lgkmcnt(2)
  v_pk_add_f32 v[96:97], v[96:97], v[160:161]
  v_pk_add_f32 v[98:99], v[98:99], v[162:163]
  v_pk_add_f32 v[100:101], v[100:101], v[164:165]
  v_pk_add_f32 v[102:103], v[102:103], v[166:167]
  v_cvt_pk_bf16_f32 v24, v96, v97
  v_cvt_pk_bf16_f32 v25, v98, v99
  v_cvt_pk_bf16_f32 v26, v100, v101
  v_cvt_pk_bf16_f32 v27, v102, v103
  v_permlane16_swap_b32 v20, v22
  v_permlane16_swap_b32 v21, v23
  buffer_store_dwordx4 v[20:23], v178, s[12:15], s43 offen offset:64 sc0 sc1
  s_waitcnt lgkmcnt(0)
  v_pk_add_f32 v[104:105], v[104:105], v[168:169]
  v_pk_add_f32 v[106:107], v[106:107], v[170:171]
  v_pk_add_f32 v[108:109], v[108:109], v[172:173]
  v_pk_add_f32 v[110:111], v[110:111], v[174:175]
  v_cvt_pk_bf16_f32 v28, v104, v105
  v_cvt_pk_bf16_f32 v29, v106, v107
  v_cvt_pk_bf16_f32 v30, v108, v109
  v_cvt_pk_bf16_f32 v31, v110, v111
  v_permlane16_swap_b32 v24, v26
  v_permlane16_swap_b32 v25, v27
  buffer_store_dwordx4 v[24:27], v178, s[12:15], s44 offen offset:0 sc0 sc1
  s_nop 1
  v_permlane16_swap_b32 v28, v30
  v_permlane16_swap_b32 v29, v31
  buffer_store_dwordx4 v[28:31], v178, s[12:15], s44 offen offset:64 sc0 sc1
L_end:
  s_endpgm
L_nonce_retry:
  buffer_load_dwordx2 v[238:239], v237, s[52:55], 0 offen sc1
  s_waitcnt vmcnt(0)
  s_branch L_nonce
L_fallback:
  v_mov_b32 v4, 0xff800000
  v_mov_b32 v6, 0xff800000
  s_mov_b32 s42, 0
  s_waitcnt vmcnt(0) lgkmcnt(0)
L_fb_max:
  s_add_u32 s7, s42, s50
  buffer_load_dwordx4 v[64:67], v3, s[36:39], s7 offen offset:0 sc1
  buffer_load_dwordx4 v[68:71], v3, s[36:39], s7 offen offset:1024 sc1
  s_waitcnt vmcnt(0)
  v_mfma_f32_32x32x16_bf16 v[128:143], v[64:67], v[16:19], 0
  v_mfma_f32_32x32x16_bf16 v[128:143], v[68:71], v[20:23], v[128:143]
  v_mfma_f32_32x32x16_bf16 v[144:159], v[64:67], v[24:27], 0
  v_mfma_f32_32x32x16_bf16 v[144:159], v[68:71], v[28:31], v[144:159]
  s_nop 15
  v_max3_f32 v4, v4, v128, v129
  v_max3_f32 v4, v4, v130, v131
  v_max3_f32 v4, v4, v132, v133
  v_max3_f32 v4, v4, v134, v135
  v_max3_f32 v4, v4, v136, v137
  v_max3_f32 v4, v4, v138, v139
  v_max3_f32 v4, v4, v140, v141
  v_max3_f32 v4, v4, v142, v143
  v_max3_f32 v6, v6, v144, v145
  v_max3_f32 v6, v6, v146, v147
  v_max3_f32 v6, v6, v148, v149
  v_max3_f32 v6, v6, v150, v151
  v_max3_f32 v6, v6, v152, v153
  v_max3_f32 v6, v6, v154, v155
  v_max3_f32 v6, v6, v156, v157
  v_max3_f32 v6, v6, v158, v159
  s_add_u32 s42, s42, 4096
  s_cmp_lt_u32 s42, 0x40000
  s_cbranch_scc1 L_fb_max
  v_mov_b32 v5, v4
  s_nop 1
  v_permlane32_swap_b32 v4, v5
  s_nop 1
  v_max_f32 v4, v4, v5
  v_sub_f32 v4, 0, v4
  v_mov_b32 v5, v4
  v_mov_b64 v[96:97], v[4:5]
  v_mov_b64 v[98:99], v[4:5]
  v_mov_b64 v[100:101], v[4:5]
  v_mov_b64 v[102:103], v[4:5]
  v_mov_b64 v[104:105], v[4:5]
  v_mov_b64 v[106:107], v[4:5]
  v_mov_b64 v[108:109], v[4:5]
  v_mov_b64 v[110:111], v[4:5]
  v_mov_b32 v7, v6
  s_nop 1
  v_permlane32_swap_b32 v6, v7
  s_nop 1
  v_max_f32 v6, v6, v7
  v_sub_f32 v6, 0, v6
  v_mov_b32 v7, v6
  v_mov_b64 v[112:113], v[6:7]
  v_mov_b64 v[114:115], v[6:7]
  v_mov_b64 v[116:117], v[6:7]
  v_mov_b64 v[118:119], v[6:7]
  v_mov_b64 v[120:121], v[6:7]
  v_mov_b64 v[122:123], v[6:7]
  v_mov_b64 v[124:125], v[6:7]
  v_mov_b64 v[126:127], v[6:7]
  v_mov_b64 v[192:193], 0
  v_mov_b64 v[194:195], 0
  v_mov_b64 v[196:197], 0
  v_mov_b64 v[198:199], 0
  v_mov_b64 v[200:201], 0
  v_mov_b64 v[202:203], 0
  v_mov_b64 v[204:205], 0
  v_mov_b64 v[206:207], 0
  v_mov_b64 v[208:209], 0
  v_mov_b64 v[210:211], 0
  v_mov_b64 v[212:213], 0
  v_mov_b64 v[214:215], 0
  v_mov_b64 v[216:217], 0
  v_mov_b64 v[218:219], 0
  v_mov_b64 v[220:221], 0
  v_mov_b64 v[222:223], 0
  v_mov_b64 v[224:225], 0
  v_mov_b64 v[226:227], 0
  v_mov_b64 v[228:229], 0
  v_mov_b64 v[230:231], 0
  s_mov_b32 s42, 0
L_fb_main:
  s_add_u32 s7, s42, s50
  buffer_load_dwordx4 v[64:67], v3, s[36:39], s7 offen offset:0 sc1
  buffer_load_dwordx4 v[68:71], v3, s[36:39], s7 offen offset:1024 sc1
  buffer_load_dwordx4 v[80:83], v3, s[36:39], s7 offen offset:2048 sc1
  buffer_load_dwordx4 v[84:87], v3, s[36:39], s7 offen offset:3072 sc1
  s_waitcnt vmcnt(0)
  v_mfma_f32_32x32x16_bf16 v[128:143], v[64:67], v[16:19], v[96:111]
  v_mfma_f32_32x32x16_bf16 v[128:143], v[68:71], v[20:23], v[128:143]
  v_mfma_f32_32x32x16_bf16 v[144:159], v[64:67], v[24:27], v[112:127]
  v_mfma_f32_32x32x16_bf16 v[144:159], v[68:71], v[28:31], v[144:159]
  s_nop 15
  v_exp_f32 v128, v128
  v_exp_f32 v129, v129
  v_exp_f32 v130, v130
  v_exp_f32 v131, v131
  v_exp_f32 v132, v132
  v_exp_f32 v133, v133
  v_exp_f32 v134, v134
  v_exp_f32 v135, v135
  v_exp_f32 v136, v136
  v_exp_f32 v137, v137
  v_exp_f32 v138, v138
  v_exp_f32 v139, v139
  v_exp_f32 v140, v140
  v_exp_f32 v141, v141
  v_exp_f32 v142, v142
  v_exp_f32 v143, v143
  v_exp_f32 v144, v144
  v_exp_f32 v145, v145
  v_exp_f32 v146, v146
  v_exp_f32 v147, v147
  v_exp_f32 v148, v148
  v_exp_f32 v149, v149
  v_exp_f32 v150, v150
  v_exp_f32 v151, v151
  v_exp_f32 v152, v152
  v_exp_f32 v153, v153
  v_exp_f32 v154, v154
  v_exp_f32 v155, v155
  v_exp_f32 v156, v156
  v_exp_f32 v157, v157
  v_exp_f32 v158, v158
  v_exp_f32 v159, v159
  s_nop 1
  v_smfmac_f32_32x32x32_bf16 v[192:207], v[80:83], v[128:135], v236
  v_smfmac_f32_16x16x64_bf16 v[224:227], v[232:235], v[128:135], v236
  v_smfmac_f32_32x32x32_bf16 v[192:207], v[84:87], v[136:143], v236
  v_smfmac_f32_16x16x64_bf16 v[224:227], v[232:235], v[136:143], v236
  v_smfmac_f32_32x32x32_bf16 v[208:223], v[80:83], v[144:151], v236
  v_smfmac_f32_16x16x64_bf16 v[228:231], v[232:235], v[144:151], v236
  v_smfmac_f32_32x32x32_bf16 v[208:223], v[84:87], v[152:159], v236
  v_smfmac_f32_16x16x64_bf16 v[228:231], v[232:235], v[152:159], v236
  s_add_u32 s42, s42, 4096
  s_cmp_lt_u32 s42, 0x40000
  s_cbranch_scc1 L_fb_main
  s_nop 15
  v_mov_b32 v225, v224
  s_nop 1
  v_permlane32_swap_b32 v224, v225
  v_mov_b32 v229, v228
  s_nop 1
  v_permlane32_swap_b32 v228, v229
  v_rcp_f32 v4, v224
  s_nop 0
  v_pk_mul_f32 v[192:193], v[192:193], v[4:5] op_sel_hi:[1,0]
  v_pk_mul_f32 v[194:195], v[194:195], v[4:5] op_sel_hi:[1,0]
  v_pk_mul_f32 v[196:197], v[196:197], v[4:5] op_sel_hi:[1,0]
  v_pk_mul_f32 v[198:199], v[198:199], v[4:5] op_sel_hi:[1,0]
  v_pk_mul_f32 v[200:201], v[200:201], v[4:5] op_sel_hi:[1,0]
  v_pk_mul_f32 v[202:203], v[202:203], v[4:5] op_sel_hi:[1,0]
  v_pk_mul_f32 v[204:205], v[204:205], v[4:5] op_sel_hi:[1,0]
  v_pk_mul_f32 v[206:207], v[206:207], v[4:5] op_sel_hi:[1,0]
  v_cvt_pk_bf16_f32 v32, v192, v193
  v_cvt_pk_bf16_f32 v33, v194, v195
  v_cvt_pk_bf16_f32 v34, v196, v197
  v_cvt_pk_bf16_f32 v35, v198, v199
  v_cvt_pk_bf16_f32 v36, v200, v201
  v_cvt_pk_bf16_f32 v37, v202, v203
  v_cvt_pk_bf16_f32 v38, v204, v205
  v_cvt_pk_bf16_f32 v39, v206, v207
  buffer_store_dwordx4 v[32:35], v10, s[36:39], s47 offen offset:0 sc1
  buffer_store_dwordx4 v[36:39], v10, s[36:39], s47 offen offset:512 sc1
  s_branch L_fin
.section .rodata,"a"
.p2align 6
.amdhsa_kernel concat_heads__mha_block__softmax_full_mha__prompt_kernel
  .amdhsa_next_free_vgpr 256
  .amdhsa_next_free_sgpr 102
  .amdhsa_accum_offset 256
  .amdhsa_group_segment_fixed_size 0
  .amdhsa_kernarg_size 72
  .amdhsa_user_sgpr_count 2
  .amdhsa_user_sgpr_kernarg_segment_ptr 1
  .amdhsa_system_sgpr_workgroup_id_x 1
.end_amdhsa_kernel
```
